```python
import torch

def _softmax(x, axis=-1):
    return torch.softmax(x, dim=axis)
def _gelu(x):
    return torch.nn.functional.gelu(x, approximate="tanh")
def _silu(x):
    return torch.nn.functional.silu(x)
def _sigmoid(x):
    return torch.sigmoid(x)
def _layernorm(x, axis=-1, eps=1e-5):
    m = x.mean(dim=axis, keepdim=True)
    v = x.var(dim=axis, keepdim=True, unbiased=False)
    return (x - m) / torch.sqrt(v + eps)
def _scatter_add(tgt, idx, src, axis=0):
    return tgt.clone().index_add_(axis, idx, src)
def _segment_sum(src, seg, n):
    out = torch.zeros((n,) + src.shape[1:], dtype=src.dtype)
    return out.index_add_(0, seg, src)
def _pad(x, pw):
    flat = tuple(v for pair in reversed(pw) for v in pair)
    return torch.nn.functional.pad(x, flat)

kernel_name = 'gated_mix__ssm_conv_s5__dense_activation_relu__prompt'

def setup_inputs():

    _w = (lambda a: (lambda t: t.to(torch.bfloat16) if t.is_floating_point() else t)(torch.as_tensor(a)))
    def _A_setup():
        B, S, D = 1, 2048, 512
        P = D
        Lambda_re = -0.5 * (lambda _x: torch.exp(torch.as_tensor(_x)))((lambda *s: torch.randn(*s, dtype=torch.bfloat16) * 0.8)(P))
        Lambda_im = (lambda *s: torch.randn(*s, dtype=torch.bfloat16) * 0.8)(P) * 1.0
        B_re = (lambda *s: torch.randn(*s, dtype=torch.bfloat16) * 0.8)(P, D) * (D ** -0.5)
        B_im = (lambda *s: torch.randn(*s, dtype=torch.bfloat16) * 0.8)(P, D) * (D ** -0.5)
        C_re = (lambda *s: torch.randn(*s, dtype=torch.bfloat16) * 0.8)(D, P) * (P ** -0.5)
        C_im = (lambda *s: torch.randn(*s, dtype=torch.bfloat16) * 0.8)(D, P) * (P ** -0.5)
        log_dt = (lambda *s: torch.randn(*s, dtype=torch.bfloat16) * 0.8)(P) * 0.3 - 2.0
        Dskip = (lambda *s: torch.randn(*s, dtype=torch.bfloat16) * 0.8)(D)
        return {
            "x": _w((lambda *s: torch.randn(*s, dtype=torch.bfloat16) * 0.05)(B, S, D)),
            "Lambda_re": _w(Lambda_re),
            "Lambda_im": _w(Lambda_im),
            "B_re": _w(B_re),
            "B_im": _w(B_im),
            "C_re": _w(C_re),
            "C_im": _w(C_im),
            "log_dt": _w(log_dt),
            "Dskip": _w(Dskip),
        }
    _A_in = _A_setup()

    def _B_setup():
        B, S, D, Dff = 1, 2048, 512, 1792
        return {
            "x": _w((lambda *s: torch.randn(*s, dtype=torch.bfloat16) * 0.05)(B, S, D)),
            "w1": _w((lambda *s: torch.randn(*s, dtype=torch.bfloat16) * 0.05)(D, Dff)),
            "w2": _w((lambda *s: torch.randn(*s, dtype=torch.bfloat16) * 0.05)(Dff, D)),
        }
    _B_in = _B_setup()

    return {
        "A_x": _A_in["x"],
        "A_Lambda_re": _A_in["Lambda_re"],
        "A_Lambda_im": _A_in["Lambda_im"],
        "A_B_re": _A_in["B_re"],
        "A_B_im": _A_in["B_im"],
        "A_C_re": _A_in["C_re"],
        "A_C_im": _A_in["C_im"],
        "A_log_dt": _A_in["log_dt"],
        "A_Dskip": _A_in["Dskip"],
        "B_x": _B_in["x"],
        "B_w1": _B_in["w1"],
        "B_w2": _B_in["w2"],
        "gate_w": _w((lambda *s: torch.randn(*s, dtype=torch.bfloat16) * 0.05)(512) * 16.0),
    }

def reference(A_x, A_Lambda_re, A_Lambda_im, A_B_re, A_B_im, A_C_re, A_C_im, A_log_dt, A_Dskip, B_x, B_w1, B_w2, gate_w):
    def _A_ref(x, Lambda_re, Lambda_im, B_re, B_im, C_re, C_im, log_dt, Dskip):
        Bsz, L, H = x.shape
        Lam = Lambda_re + 1j * Lambda_im
        Bmat = B_re + 1j * B_im
        Cmat = C_re + 1j * C_im
        dt = torch.exp(log_dt)
        Lam_bar = torch.exp(dt * Lam)
        B_bar = ((Lam_bar - 1.0) / Lam)[:, None] * Bmat
        Bu = torch.einsum("bld,pd->blp", x + 0j, B_bar)
        h = torch.zeros_like(Bu[:, 0, :])
        hs = []
        for t in range(L):
            h = Lam_bar[None, :] * h + Bu[:, t, :]
            hs.append(h)
        hseq = torch.stack(hs, 1)
        y = 2.0 * torch.einsum("blp,dp->bld", hseq, Cmat).real + x * Dskip[None, None, :]
        return y

    def _B_ref(x, w1, w2):
        h = torch.einsum("bsd,df->bsf", x, w1)
        zero = torch.zeros_like(h)
        h = torch.maximum(h, zero)
        return torch.einsum("bsf,fd->bsd", h, w2)

    x = A_x
    g = _sigmoid((x * gate_w).sum(-1, keepdims=True))
    a = _A_ref(x, A_Lambda_re, A_Lambda_im, A_B_re, A_B_im, A_C_re, A_C_im, A_log_dt, A_Dskip)
    b = _B_ref(x, B_w1, B_w2)
    return g * a + (1 - g) * b
```

```asm
; @launch grid=(256,1,1) block=(256,1,1) lds=163840
.amdgcn_target "amdgcn-amd-amdhsa--gfx950"
.text
.globl gated_mix__ssm_conv_s5__dense_activation_relu__prompt_kernel
.p2align 8
.type gated_mix__ssm_conv_s5__dense_activation_relu__prompt_kernel,@function
gated_mix__ssm_conv_s5__dense_activation_relu__prompt_kernel:
    s_cmp_ge_u32 s2, 256
    s_cbranch_scc1 L_end
    s_load_dwordx16 s[64:79], s[0:1], 0
    s_load_dwordx16 s[80:95], s[0:1], 64
    v_lshrrev_b32 v2, 6, v0
    v_and_b32 v1, 63, v0
    v_readfirstlane_b32 s36, v2
    v_lshrrev_b32 v200, 3, v1
    v_and_b32 v201, 7, v1
    v_lshrrev_b32 v202, 1, v200
    v_xor_b32 v203, v201, v202
    v_lshlrev_b32 v203, 4, v203
    v_lshl_add_u32 v6, v200, 10, v203
    v_lshrrev_b32 v201, 2, v200
    v_and_b32_e64 v202, 3, v200
    v_lshl_add_u32 v201, v201, 4, v202
    v_lshl_add_u32 v2, v201, 10, v203
    v_xor_b32_e64 v3, 64, v2
    v_add_u32 v3, 31744, v3
    v_add_u32 v4, 2048, v2
    v_add_u32 v5, 2048, v3
    s_bfe_u32 s51, s2, 0x30003
    s_and_b32 s37, s2, 1
    s_lshl_b32 s37, s37, 3
    s_add_u32 s37, s37, s51
    s_lshr_b32 s40, s2, 6
    s_bfe_u32 s39, s2, 0x20001
    s_mov_b32 s6, 0x200000
    s_mov_b32 s7, 0x20000
    s_add_u32 s57, s37, s40
    s_mul_i32 s57, s57, 3
    s_and_b32 s57, s57, 7
    s_mul_i32 s57, s57, 3
    s_lshr_b32 s57, s57, 3
    s_mul_i32 s57, s57, 3
    s_lshr_b32 s99, s36, 1
    s_and_b32 s100, s36, 1
    s_lshl_b32 s54, s37, 17
    s_lshl_b32 s49, s99, 16
    s_add_u32 s54, s54, s49
    s_lshl_b32 s49, s100, 13
    s_add_u32 s54, s54, s49
    s_lshl_b32 s46, s36, 12
    s_lshl_b32 s44, s57, 7
    s_mov_b32 m0, s46
    s_add_u32 s43, s54, s44
    s_waitcnt lgkmcnt(0)
    s_mov_b32 s4, s64
    s_mov_b32 s5, s65
    buffer_load_dwordx4 v2, s[4:7], s43 offen offset:0 lds
    buffer_load_dwordx4 v3, s[4:7], s43 offen offset:1024 lds
    buffer_load_dwordx4 v4, s[4:7], s43 offen offset:2048 lds
    buffer_load_dwordx4 v5, s[4:7], s43 offen offset:3072 lds
    s_lshl_b32 s38, s39, 2
    s_add_u32 s38, s38, s40
    v_and_b32 v200, 15, v1
    v_lshlrev_b32 v200, 1, v200
    v_lshlrev_b32 v43, 4, v1
    s_lshl_b32 s49, s38, 6
    s_lshl_b32 s50, s100, 5
    s_add_u32 s49, s49, s50
    v_add_u32 v200, s49, v200
    s_lshl_b32 s50, s38, 11
    s_lshl_b32 s49, s37, 17
    s_add_u32 s50, s50, s49
    s_lshl_b32 s49, s36, 15
    s_add_u32 s50, s50, s49
    v_add_u32_e64 v201, s50, v43
    global_load_dwordx4 v[64:67], v43, s[88:89]
    global_load_dwordx4 v[56:59], v201, s[64:65]
    global_load_dwordx4 v[60:63], v201, s[64:65] offset:1024
    global_load_ushort v54, v200, s[78:79]
    global_load_ushort v52, v200, s[66:67]
    global_load_ushort v53, v200, s[68:69]
    s_getpc_b64 s[58:59]
L_pc:
    s_lshr_b32 s49, s2, 3
    s_lshl_b32 s49, s49, 2
    s_add_u32 s49, s49, s36
    s_mul_i32 s49, s49, 168
    s_min_u32 s49, s49, L_end-L_pc-112
    s_add_u32 s58, s58, s49
    s_addc_u32 s59, s59, 0
    s_load_dword s60, s[58:59], 0
    s_load_dword s61, s[58:59], 56
    s_load_dword s62, s[58:59], 112
    s_load_dword s63, s[94:95], 0
    s_mov_b32 s10, 0x80000
    s_mov_b32 s11, 0x20000
    s_mov_b32 s14, 0x1c0000
    s_mov_b32 s15, 0x20000
    v_xor_b32 v7, 64, v6
    v_add_u32 v7, 7168, v7
    s_lshl_b32 s55, s38, 15
    s_lshl_b32 s49, s100, 14
    s_add_u32 s55, s55, s49
    s_lshl_b32 s47, s36, 11
    s_add_u32 s47, s47, 131072
    s_cmp_ge_u32 s36, 2
    s_cselect_b32 s8, s72, s70
    s_cselect_b32 s9, s73, s71
    s_mov_b32 m0, s47
    s_add_u32 s44, s55, s44
    buffer_load_dwordx4 v6, s[8:11], s44 offen offset:0 lds
    buffer_load_dwordx4 v7, s[8:11], s44 offen offset:1024 lds
    v_lshrrev_b32 v200, 4, v1
    v_and_b32 v201, 15, v1
    v_lshlrev_b32 v202, 2, v200
    v_xor_b32 v14, v201, v202
    v_lshrrev_b32 v202, 2, v14
    v_cmp_eq_u32 vcc, 3, v202
    v_mul_u32_u24 v200, 3584, v200
    v_lshl_add_u32 v10, v14, 4, v200
    s_lshr_b32 s98, s40, 1
    s_cselect_b64 s[58:59], vcc, 0
    v_mov_b32 v203, 0x80000000
    s_nop 0
    v_cndmask_b32 v10, v10, v203, s[58:59]
    v_add_u32 v11, 13312, v10
    v_xor_b32_e64 v12, 32, v10
    v_add_u32 v13, 39936, v12
    v_add_u32 v12, 26624, v12
    s_lshl_b32 s3, s40, 3
    s_min_u32 s3, s3, 22
    s_mul_i32 s49, s39, 896
    s_lshl_b32 s50, s3, 5
    s_add_u32 s49, s49, s50
    s_mul_i32 s56, s36, 57344
    s_add_u32 s56, s56, s49
    s_add_u32 s48, s46, 65536
    s_mov_b32 s12, s84
    s_mov_b32 s13, s85
    s_mul_i32 s45, s57, 229376
    s_mov_b32 m0, s48
    s_add_u32 s45, s45, s56
    buffer_load_dwordx4 v10, s[12:15], s45 offen offset:0 lds
    buffer_load_dwordx4 v11, s[12:15], s45 offen offset:1024 lds
    buffer_load_dwordx4 v12, s[12:15], s45 offen offset:2048 lds
    buffer_load_dwordx4 v13, s[12:15], s45 offen offset:3072 lds
    s_add_u32 s57, s57, 1
    s_and_b32 s57, s57, 7
    s_mov_b32 s18, 0x1c0000
    s_mov_b32 s19, 0x20000
    s_mov_b32 s22, 0x80000
    s_mov_b32 s23, 0x20000
    s_mov_b32 s26, 0x80000
    s_mov_b32 s27, 0x20000
    s_mov_b32 s30, 0x1160000
    s_mov_b32 s31, 0x20000
    s_mov_b32 s34, 0x400000
    s_mov_b32 s35, 0x20000
    s_mov_b32 s42, 0xffff0000
    s_mov_b32 s16, s86
    s_mov_b32 s17, s87
    s_mov_b32 s20, s74
    s_mov_b32 s21, s75
    s_mov_b32 s24, s76
    s_mov_b32 s25, s77
    s_mov_b32 s28, s94
    s_mov_b32 s29, s95
    s_mov_b32 s32, s90
    s_mov_b32 s33, s91
    v_and_b32 v200, 15, v1
    v_lshrrev_b32 v201, 4, v1
    v_lshrrev_b32 v202, 1, v200
    v_xor_b32 v202, v202, v201
    v_lshlrev_b32 v202, 4, v202
    v_lshl_add_u32 v202, v200, 7, v202
    s_lshl_b32 s49, s99, 13
    s_lshl_b32 s50, s100, 11
    s_add_u32 s50, s50, 131072
    v_add_u32 v18, s49, v202
    v_add_u32 v20, s50, v202
    v_xor_b32 v19, 64, v18
    v_xor_b32 v21, 64, v20
    s_lshl_b32 s49, s99, 2
    v_add_u32_e64 v42, s49, v201
    v_bfe_u32 v200, v1, 2, 2
    v_lshl_add_u32 v202, v201, 3, v200
    v_lshlrev_b32 v202, 8, v202
    v_lshl_add_u32 v202, v200, 6, v202
    v_and_b32 v203, 1, v201
    v_lshl_add_u32 v202, v203, 5, v202
    v_and_b32_e64 v203, 3, v1
    v_lshl_add_u32 v202, v203, 3, v202
    v_add_u32 v202, 0x10000, v202
    s_mul_i32 s49, s100, 96
    v_xor_b32 v22, s49, v202
    s_add_u32 s50, s49, 32
    v_xor_b32 v23, s50, v202
    s_add_u32 s50, s49, 64
    v_xor_b32 v24, s50, v202
    s_lshl_b32 s50, s100, 5
    s_add_u32 s50, s50, 192
    v_xor_b32 v25, s50, v202
    s_cmp_eq_u32 s36, 0
    s_cbranch_scc1 L_pad1
    s_cmp_eq_u32 s36, 1
    s_cbranch_scc1 L_pad2
    s_cmp_eq_u32 s36, 2
    s_cbranch_scc1 L_pad3
    s_cmp_eq_u32 s36, 3
    s_cbranch_scc1 L_pad4
L_touch_ret:
    s_waitcnt lgkmcnt(0)
    s_mul_i32 s41, s63, 0x9e3779b1
    s_add_u32 s41, s41, 0x7f4a7c15
    s_cmp_lg_u32 s98, 0
    s_cselect_b64 vcc, -1, 0
    s_lshl_b32 s49, s100, 4
    v_and_b32 v206, 15, v1
    v_add_u32 v206, s49, v206
    v_lshl_add_u32 v0, v42, 5, v206
    v_lshlrev_b32 v0, 3, v0
    v_add_u32 v0, 0x24000, v0
    v_mov_b32 v203, 0x80000000
    v_mov_b32 v45, s41
    s_lshl_b32 s44, s57, 7
    s_add_u32 m0, s46, 16384
    s_add_u32 s43, s54, s44
    buffer_load_dwordx4 v2, s[4:7], s43 offen offset:0 lds
    v_cndmask_b32 v44, v43, v203, vcc
    v_add_u32 v8, 14336, v6
    v_add_u32 v9, 14336, v7
    s_lshl_b32 s49, s39, 2
    v_add_u32 v14, s49, v14
    v_and_b32 v14, 15, v14
    v_lshlrev_b32 v14, 4, v14
    v_lshrrev_b32_e64 v200, 4, v1
    v_lshl_add_u32 v14, v200, 10, v14
    v_add_u32 v15, 3072, v14
    v_add_u32 v16, 6144, v14
    v_add_u32 v17, 9216, v14
    s_lshr_b32 s49, s40, 1
    s_add_u32 s50, s36, s39
    s_and_b32 s50, s50, 3
    s_lshl_b32 s50, s50, 15
    s_lshl_b32 s61, s40, 17
    s_add_u32 s61, s61, s50
    s_lshl_b32 s50, s39, 8
    s_add_u32 s61, s61, s50
    s_lshl_b32 s49, s49, 7
    s_add_u32 s61, s61, s49
    s_lshl_b32 s49, s37, 10
    s_lshl_b32 s50, s99, 9
    buffer_load_dwordx4 v3, s[4:7], s43 offen offset:1024 lds
    s_add_u32 s49, s49, s50
    s_add_u32 s49, s49, 135168
    v_lshl_add_u32 v81, v1, 3, s49
    s_lshl_b32 s49, s40, 8
    s_lshl_b32 s50, s39, 6
    s_add_u32 s49, s49, s50
    v_bfe_u32 v200, v1, 4, 1
    v_lshlrev_b32 v200, 5, v200
    v_lshrrev_b32 v201, 5, v1
    v_lshl_add_u32 v200, v201, 2, v200
    v_bfe_u32 v201, v1, 2, 2
    v_add_u32 v200, v200, v201
    v_and_b32 v202, 3, v1
    v_lshlrev_b32_e64 v202, 4, v202
    v_lshl_add_u32 v82, v200, 10, v202
    v_add_u32 v83, 15360, v82
    s_add_u32 s69, s49, s54
    v_and_b32 v202, 31, v1
    v_lshlrev_b32 v202, 1, v202
    v_add_u32_e64 v84, s49, v202
    s_lshl_b32 s49, s36, 9
    s_add_u32 s49, s49, 151552
    v_lshl_add_u32 v96, v1, 2, s49
    v_lshrrev_b32 v200, 4, v1
    v_and_b32 v201, 3, v1
    v_lshl_add_u32 v201, v200, 2, v201
    v_bfe_u32 v202, v1, 2, 2
    v_lshl_add_u32 v201, v201, 2, v202
    v_lshl_add_u32 v97, v201, 2, s49
    v_lshl_add_u32 v99, v200, 6, s49
    v_and_b32_e64 v201, 15, v1
    v_lshl_add_u32 v98, v201, 4, s49
    buffer_load_dwordx4 v4, s[4:7], s43 offen offset:2048 lds
    s_lshl_b32 s50, s100, 5
    s_add_u32 s49, s49, s50
    v_lshrrev_b32_e64 v201, 5, v1
    v_lshl_add_u32 v100, v201, 6, s49
    s_add_u32 s49, s46, 32768
    v_add_u32 v102, s49, v43
    v_xor_b32 v101, 0x1000, v102
    v_and_b32 v200, 31, v1
    v_bfe_u32 v202, v200, 1, 3
    v_xor_b32 v202, v202, v201
    v_lshlrev_b32_e64 v202, 4, v202
    v_lshl_add_u32 v103, v200, 7, v202
    s_lshl_b32 s49, s37, 2
    s_add_u32 s49, s49, s36
    s_mul_i32 s63, s49, 180224
    s_add_u32 s63, s63, 393216
    s_lshl_b32 s71, s49, 9
    s_lshl_b32 s50, s39, 7
    s_add_u32 s71, s71, s50
    s_add_u32 s71, s71, 151552
    s_lshl_b32 s50, s40, 2
    s_add_u32 s68, s71, s50
    s_mul_i32 s83, s39, 28672
    s_add_u32 s83, s83, s63
    buffer_load_dwordx4 v5, s[4:7], s43 offen offset:3072 lds
    s_lshl_b32 s62, s3, 10
    s_lshl_b32 s82, s39, 14
    s_add_u32 s82, s82, s63
    s_add_u32 s82, s82, 114688
    v_mov_b32 v203, 0x80000000
    s_mul_i32 s53, s39, 458752
    s_lshl_b32 s49, s40, 8
    s_add_u32 s53, s53, s49
    s_and_b32 s49, s37, 7
    s_mul_i32 s50, s49, 56
    s_mul_i32 s51, s36, 14
    s_add_u32 s50, s50, s51
    v_lshrrev_b32 v200, 1, v1
    v_add_u32 v200, s50, v200
    v_lshlrev_b32 v200, 10, v200
    v_and_b32 v201, 1, v1
    v_lshl_add_u32 v200, v201, 7, v200
    v_cmp_gt_u32 s[58:59], 28, v1
    s_lshl_b32 s49, s49, 4
    s_and_b32 s50, s36, 1
    s_lshl_b32 s50, s50, 3
    s_add_u32 s49, s49, s50
    v_cndmask_b32 v240, v203, v200, s[58:59]
    v_lshrrev_b32 v200, 1, v1
    s_add_u32 m0, s47, 8192
    s_add_u32 s44, s55, s44
    buffer_load_dwordx4 v6, s[8:11], s44 offen offset:0 lds
    v_add_u32 v200, s49, v200
    v_lshlrev_b32 v200, 10, v200
    v_lshl_add_u32 v200, v201, 7, v200
    v_cmp_gt_u32 s[58:59], 16, v1
    s_lshl_b32 s49, s40, 17
    s_lshl_b32 s50, s39, 8
    s_add_u32 s70, s49, s50
    v_cndmask_b32 v241, v203, v200, s[58:59]
    s_cmp_ge_u32 s36, 2
    s_cselect_b32 s88, s76, s74
    s_cselect_b32 s89, s77, s75
    s_mov_b32 s90, 0x80000
    s_mov_b32 s91, 0x20000
    s_waitcnt vmcnt(14)
    v_lshlrev_b32 v74, 16, v64
    v_and_b32 v75, s42, v64
    v_lshlrev_b32 v76, 16, v56
    v_and_b32 v77, s42, v56
    v_lshlrev_b32 v78, 16, v60
    v_and_b32 v79, s42, v60
    v_mul_f32 v76, v76, v74
    v_mul_f32 v77, v77, v75
    v_mul_f32 v78, v78, v74
    v_mul_f32_e64 v79, v79, v75
    buffer_load_dwordx4 v7, s[8:11], s44 offen offset:1024 lds
    v_cvt_pk_bf16_f32 v76, v76, v77
    v_cvt_pk_bf16_f32 v78, v78, v79
    v_and_b32 v77, s42, v76
    v_lshlrev_b32 v76, 16, v76
    v_and_b32 v79, s42, v78
    v_lshlrev_b32 v78, 16, v78
    v_add_f32 v70, v76, v77
    v_add_f32 v72, v78, v79
    v_lshlrev_b32 v74, 16, v65
    v_and_b32 v75, s42, v65
    v_lshlrev_b32 v76, 16, v57
    v_and_b32 v77, s42, v57
    v_lshlrev_b32 v78, 16, v61
    v_and_b32 v79, s42, v61
    v_mul_f32 v76, v76, v74
    v_mul_f32 v77, v77, v75
    v_mul_f32 v78, v78, v74
    v_mul_f32 v79, v79, v75
    v_cvt_pk_bf16_f32 v76, v76, v77
    v_cvt_pk_bf16_f32 v78, v78, v79
    v_and_b32 v77, s42, v76
    v_lshlrev_b32 v76, 16, v76
    v_and_b32 v79, s42, v78
    v_lshlrev_b32 v78, 16, v78
    s_mul_i32 s45, s57, 229376
    s_add_u32 m0, s48, 16384
    s_add_u32 s45, s45, s56
    buffer_load_dwordx4 v10, s[12:15], s45 offen offset:0 lds
    v_add_f32 v70, v70, v76
    v_add_f32 v72, v72, v78
    v_add_f32 v70, v70, v77
    v_add_f32 v72, v72, v79
    v_lshlrev_b32 v74, 16, v66
    v_and_b32 v75, s42, v66
    v_lshlrev_b32 v76, 16, v58
    v_and_b32 v77, s42, v58
    v_lshlrev_b32 v78, 16, v62
    v_and_b32 v79, s42, v62
    v_mul_f32 v76, v76, v74
    v_mul_f32 v77, v77, v75
    v_mul_f32 v78, v78, v74
    v_mul_f32_e64 v79, v79, v75
    v_cvt_pk_bf16_f32 v76, v76, v77
    v_cvt_pk_bf16_f32 v78, v78, v79
    v_and_b32 v77, s42, v76
    v_lshlrev_b32 v76, 16, v76
    v_and_b32 v79, s42, v78
    v_lshlrev_b32 v78, 16, v78
    v_add_f32 v70, v70, v76
    v_add_f32 v72, v72, v78
    v_add_f32 v70, v70, v77
    v_add_f32 v72, v72, v79
    v_lshlrev_b32 v74, 16, v67
    v_and_b32 v75, s42, v67
    v_lshlrev_b32 v76, 16, v59
    v_and_b32 v77, s42, v59
    v_lshlrev_b32 v78, 16, v63
    v_and_b32 v79, s42, v63
    v_mul_f32 v76, v76, v74
    v_mul_f32 v77, v77, v75
    buffer_load_dwordx4 v11, s[12:15], s45 offen offset:1024 lds
    v_mul_f32 v78, v78, v74
    v_mul_f32 v79, v79, v75
    v_cvt_pk_bf16_f32 v76, v76, v77
    v_cvt_pk_bf16_f32 v78, v78, v79
    v_and_b32 v77, s42, v76
    v_lshlrev_b32 v76, 16, v76
    v_and_b32 v79, s42, v78
    v_lshlrev_b32 v78, 16, v78
    v_add_f32 v70, v70, v76
    v_add_f32 v72, v72, v78
    v_add_f32 v70, v70, v77
    v_add_f32_e64 v72, v72, v79
    s_nop 0
    v_add_f32_dpp v70, v70, v70 row_shr:1 row_mask:0xf bank_mask:0xf
    v_add_f32_dpp v72, v72, v72 row_shr:1 row_mask:0xf bank_mask:0xf
    s_nop 0
    v_add_f32_dpp v70, v70, v70 row_shr:2 row_mask:0xf bank_mask:0xf
    v_add_f32_dpp v72, v72, v72 row_shr:2 row_mask:0xf bank_mask:0xf
    s_nop 0
    v_add_f32_dpp v70, v70, v70 row_shr:4 row_mask:0xf bank_mask:0xf
    v_add_f32_dpp v72, v72, v72 row_shr:4 row_mask:0xf bank_mask:0xf
    s_nop 0
    v_add_f32_dpp v70, v70, v70 row_shr:8 row_mask:0xf bank_mask:0xf
    v_add_f32_dpp v72, v72, v72 row_shr:8 row_mask:0xf bank_mask:0xf
    buffer_load_dwordx4 v12, s[12:15], s45 offen offset:2048 lds
    s_nop 0
    v_add_f32_dpp v70, v70, v70 row_bcast:15 row_mask:0xa bank_mask:0xf
    v_add_f32_dpp v72, v72, v72 row_bcast:15 row_mask:0xa bank_mask:0xf
    s_nop 0
    v_add_f32_dpp v70, v70, v70 row_bcast:31 row_mask:0xc bank_mask:0xf
    v_add_f32_dpp v72, v72, v72 row_bcast:31 row_mask:0xc bank_mask:0xf
    s_nop 0
    v_cvt_pk_bf16_f32 v76, v70, v72
    v_and_b32 v72, s42, v76
    v_lshlrev_b32 v70, 16, v76
    v_mul_f32 v70, 0xbfb8aa3b, v70
    v_mul_f32 v72, 0xbfb8aa3b, v72
    v_exp_f32 v70, v70
    v_exp_f32 v72, v72
    s_nop 0
    v_add_f32 v70, 1.0, v70
    v_add_f32 v72, 1.0, v72
    v_rcp_f32 v70, v70
    v_rcp_f32_e64 v72, v72
    v_cmp_eq_u32 s[58:59], 63, v1
    buffer_load_dwordx4 v13, s[12:15], s45 offen offset:3072 lds
    s_add_u32 s57, s57, 1
    s_and_b32 s57, s57, 7
    v_cvt_pk_bf16_f32 v76, v70, v72
    v_mov_b32 v71, s41
    v_mov_b32 v73, s41
    v_and_b32 v72, s42, v76
    v_lshlrev_b32 v70, 16, v76
    s_lshl_b32 s49, s37, 10
    s_lshl_b32 s50, s36, 8
    s_add_u32 s49, s49, s50
    s_add_u32 s49, s49, 135168
    s_lshl_b32 s50, s38, 4
    s_add_u32 s50, s50, s49
    v_mov_b32 v78, s50
    v_cndmask_b32 v78, v203, v78, s[58:59]
    buffer_store_dwordx4 v[70:73], v78, s[28:31], 0 offen sc1
    s_lshl_b32 s49, s37, 4
    s_add_u32 s49, s49, s38
    s_lshl_b32 s49, s49, 2
    s_add_u32 s49, s49, s36
    s_lshl_b32 s49, s49, 7
    v_lshlrev_b32 v89, 15, v1
    v_add_u32_e64 v89, s71, v89
    s_add_u32 s50, s49, 217088
    v_writelane_b32 v89, s50, 2
    s_add_u32 s50, s49, 4096
    v_writelane_b32 v89, s50, 3
    s_waitcnt vmcnt(11)
    s_barrier
    ds_read_b128 a[136:139], v18 offset:0
    ds_read_b128 a[152:155], v20 offset:0
    ds_read_b128 a[140:143], v18 offset:2048
    ds_read_b128 a[144:147], v18 offset:4096
    ds_read_b128 a[148:151], v18 offset:6144
    ds_read_b128 a[156:159], v20 offset:4096
    ds_read_b64_tr_b16 a[160:161], v22 offset:0
    ds_read_b64_tr_b16 a[162:163], v22 offset:1024
    ds_read_b64_tr_b16 a[164:165], v23 offset:0
    ds_read_b64_tr_b16 a[166:167], v23 offset:1024
    ds_read_b64_tr_b16 a[168:169], v24 offset:0
    ds_read_b64_tr_b16 a[170:171], v24 offset:1024
    ds_read_b64_tr_b16 a[172:173], v25 offset:0
    ds_read_b64_tr_b16 a[174:175], v25 offset:1024
    s_waitcnt lgkmcnt(6)
    v_mfma_f32_16x16x32_bf16 v[104:107], a[136:139], a[152:155], 0
    global_load_ushort v29, v84, s[80:81]
    s_lshl_b32 s44, s57, 7
    v_mfma_f32_16x16x32_bf16 v[108:111], a[140:143], a[152:155], 0
    ds_read_b128 a[176:179], v19 offset:0
    s_add_u32 m0, s46, 32768
    v_mfma_f32_16x16x32_bf16 v[112:115], a[144:147], a[152:155], 0
    ds_read_b128 a[192:195], v21 offset:0
    s_add_u32 s43, s54, s44
    s_nop 0
    v_mfma_f32_16x16x32_bf16 v[116:119], a[148:151], a[152:155], 0
    ds_read_b128 a[180:183], v19 offset:2048
    buffer_load_dwordx4 v2, s[4:7], s43 offen offset:0 lds
    v_mfma_f32_16x16x32_bf16 v[120:123], a[136:139], a[156:159], 0
    ds_read_b128 a[184:187], v19 offset:4096
    buffer_load_dwordx4 v3, s[4:7], s43 offen offset:1024 lds
    v_mfma_f32_16x16x32_bf16 v[124:127], a[140:143], a[156:159], 0
    ds_read_b128 a[188:191], v19 offset:6144
    v_mfma_f32_16x16x32_bf16 v[128:131], a[144:147], a[156:159], 0
    ds_read_b128 a[196:199], v21 offset:4096
    buffer_load_dwordx4 v4, s[4:7], s43 offen offset:2048 lds
    v_mfma_f32_16x16x32_bf16 v[132:135], a[148:151], a[156:159], 0
    buffer_load_dwordx4 v5, s[4:7], s43 offen offset:3072 lds
    s_waitcnt lgkmcnt(6)
    v_mfma_f32_16x16x32_bf16 v[136:139], a[160:163], a[136:139], 0
    s_add_u32 m0, s47, 16384
    s_add_u32 s44, s55, s44
    v_mfma_f32_16x16x32_bf16 v[140:143], a[160:163], a[140:143], 0
    ds_read_b64_tr_b16 a[200:201], v22 offset:8192
    buffer_load_dwordx4 v6, s[8:11], s44 offen offset:0 lds
    v_mfma_f32_16x16x32_bf16 v[144:147], a[160:163], a[144:147], 0
    ds_read_b64_tr_b16 a[202:203], v22 offset:9216
    v_lshlrev_b32_e64 v54, 16, v54
    v_mfma_f32_16x16x32_bf16 v[148:151], a[160:163], a[148:151], 0
    ds_read_b64_tr_b16 a[204:205], v23 offset:8192
    buffer_load_dwordx4 v7, s[8:11], s44 offen offset:1024 lds
    v_mfma_f32_16x16x32_bf16 v[152:155], a[164:167], a[136:139], 0
    ds_read_b64_tr_b16 a[206:207], v23 offset:9216
    s_mul_i32 s45, s57, 229376
    v_mfma_f32_16x16x32_bf16 v[156:159], a[164:167], a[140:143], 0
    ds_read_b64_tr_b16 a[208:209], v24 offset:8192
    s_add_u32 m0, s48, 32768
    v_mfma_f32_16x16x32_bf16 v[160:163], a[164:167], a[144:147], 0
    ds_read_b64_tr_b16 a[210:211], v24 offset:9216
    s_add_u32 s45, s45, s56
    buffer_load_dwordx4 v10, s[12:15], s45 offen offset:0 lds
    v_mfma_f32_16x16x32_bf16 v[164:167], a[164:167], a[148:151], 0
    buffer_load_dwordx4 v11, s[12:15], s45 offen offset:1024 lds
    v_mul_f32 v54, 0x3fb8aa3b, v54
    v_mfma_f32_16x16x32_bf16 v[168:171], a[168:171], a[136:139], 0
    buffer_load_dwordx4 v12, s[12:15], s45 offen offset:2048 lds
    v_exp_f32 v54, v54
    v_mfma_f32_16x16x32_bf16 v[172:175], a[168:171], a[140:143], 0
    v_lshlrev_b32 v52, 16, v52
    v_lshlrev_b32 v53, 16, v53
    v_mfma_f32_16x16x32_bf16 v[176:179], a[168:171], a[144:147], 0
    buffer_load_dwordx4 v13, s[12:15], s45 offen offset:3072 lds
    s_add_u32 s57, s57, 1
    v_mfma_f32_16x16x32_bf16 v[180:183], a[168:171], a[148:151], 0
    s_and_b32 s57, s57, 7
    s_cbranch_vccnz L_sk0
    s_waitcnt lgkmcnt(12)
    v_mfma_f32_16x16x32_bf16 v[184:187], a[172:175], a[136:139], 0
    ds_read_b64_tr_b16 a[212:213], v25 offset:8192
    v_mfma_f32_16x16x32_bf16 v[188:191], a[172:175], a[140:143], 0
    ds_read_b64_tr_b16 a[214:215], v25 offset:9216
    v_mfma_f32_16x16x32_bf16 v[192:195], a[172:175], a[144:147], 0
    v_mfma_f32_16x16x32_bf16 v[196:199], a[172:175], a[148:151], 0
L_sk0:
    s_waitcnt lgkmcnt(6)
    v_mfma_f32_16x16x32_bf16 v[104:107], a[176:179], a[192:195], v[104:107]
    s_waitcnt vmcnt(12)
    s_barrier
    s_branch L_pg1
.p2align 12
L_pad1:
    s_branch L_pad5
    s_nop 0
L_pg1:
    v_mfma_f32_16x16x32_bf16 v[108:111], a[180:183], a[192:195], v[108:111]
    ds_read_b128 a[136:139], v18 offset:16384
    s_lshl_b32 s44, s57, 7
    v_mfma_f32_16x16x32_bf16 v[112:115], a[184:187], a[192:195], v[112:115]
    ds_read_b128 a[152:155], v20 offset:8192
    s_add_u32 m0, s46, 49152
    v_mfma_f32_16x16x32_bf16 v[116:119], a[188:191], a[192:195], v[116:119]
    ds_read_b128 a[140:143], v18 offset:18432
    s_add_u32 s43, s54, s44
    v_mfma_f32_16x16x32_bf16 v[120:123], a[176:179], a[196:199], v[120:123]
    ds_read_b128 a[144:147], v18 offset:20480
    buffer_load_dwordx4 v2, s[4:7], s43 offen offset:0 lds
    v_mfma_f32_16x16x32_bf16 v[124:127], a[180:183], a[196:199], v[124:127]
    ds_read_b128 a[148:151], v18 offset:22528
    v_cvt_pk_bf16_f32 v54, v54, v54
    v_mfma_f32_16x16x32_bf16 v[128:131], a[184:187], a[196:199], v[128:131]
    ds_read_b128 a[156:159], v20 offset:12288
    buffer_load_dwordx4 v3, s[4:7], s43 offen offset:1024 lds
    v_mfma_f32_16x16x32_bf16 v[132:135], a[188:191], a[196:199], v[132:135]
    v_lshlrev_b32 v54, 16, v54
    s_waitcnt lgkmcnt(6)
    v_mfma_f32_16x16x32_bf16 v[136:139], a[200:203], a[176:179], v[136:139]
    v_mul_f32 v68, v54, v52
    v_mul_f32 v69, v54, v53
    v_mfma_f32_16x16x32_bf16 v[140:143], a[200:203], a[180:183], v[140:143]
    ds_read_b64_tr_b16 a[160:161], v22 offset:16384
    v_mul_f32 v68, 0x3fb8aa3b, v68
    v_mfma_f32_16x16x32_bf16 v[144:147], a[200:203], a[184:187], v[144:147]
    ds_read_b64_tr_b16 a[162:163], v22 offset:17408
    buffer_load_dwordx4 v4, s[4:7], s43 offen offset:2048 lds
    v_mfma_f32_16x16x32_bf16 v[148:151], a[200:203], a[188:191], v[148:151]
    ds_read_b64_tr_b16 a[164:165], v23 offset:16384
    v_mul_f32_e64 v69, 0x3e22f983, v69
    v_mfma_f32_16x16x32_bf16 v[152:155], a[204:207], a[176:179], v[152:155]
    ds_read_b64_tr_b16 a[166:167], v23 offset:17408
    v_cvt_f32_u32_e64 v203, v42
    v_mfma_f32_16x16x32_bf16 v[156:159], a[204:207], a[180:183], v[156:159]
    ds_read_b64_tr_b16 a[168:169], v24 offset:16384
    buffer_load_dwordx4 v5, s[4:7], s43 offen offset:3072 lds
    v_mfma_f32_16x16x32_bf16 v[160:163], a[204:207], a[184:187], v[160:163]
    ds_read_b64_tr_b16 a[170:171], v24 offset:17408
    s_add_u32 m0, s47, 24576
    v_mfma_f32_16x16x32_bf16 v[164:167], a[204:207], a[188:191], v[164:167]
    s_add_u32 s44, s55, s44
    v_exp_f32 v200, v68
    v_mfma_f32_16x16x32_bf16 v[168:171], a[208:211], a[176:179], v[168:171]
    v_fract_f32 v201, v69
    v_cos_f32 v30, v201
    v_mfma_f32_16x16x32_bf16 v[172:175], a[208:211], a[180:183], v[172:175]
    buffer_load_dwordx4 v6, s[8:11], s44 offen offset:0 lds
    v_sin_f32 v31, v201
    v_mfma_f32_16x16x32_bf16 v[176:179], a[208:211], a[184:187], v[176:179]
    s_nop 0
    v_mul_f32_e64 v30, v30, v200
    v_mfma_f32_16x16x32_bf16 v[180:183], a[208:211], a[188:191], v[180:183]
    s_cbranch_vccnz L_sk1
    s_waitcnt lgkmcnt(12)
    v_mfma_f32_16x16x32_bf16 v[184:187], a[212:215], a[176:179], v[184:187]
    ds_read_b64_tr_b16 a[172:173], v25 offset:16384
    v_mfma_f32_16x16x32_bf16 v[188:191], a[212:215], a[180:183], v[188:191]
    ds_read_b64_tr_b16 a[174:175], v25 offset:17408
    v_mfma_f32_16x16x32_bf16 v[192:195], a[212:215], a[184:187], v[192:195]
    v_mfma_f32_16x16x32_bf16 v[196:199], a[212:215], a[188:191], v[196:199]
L_sk1:
    s_waitcnt lgkmcnt(6)
    v_mfma_f32_16x16x32_bf16 v[104:107], a[136:139], a[152:155], v[104:107]
    v_mul_f32 v31, v31, v200
    v_mul_f32 v200, 0x41800000, v68
    v_mfma_f32_16x16x32_bf16 v[108:111], a[140:143], a[152:155], v[108:111]
    ds_read_b128 a[176:179], v19 offset:16384
    buffer_load_dwordx4 v7, s[8:11], s44 offen offset:1024 lds
    v_mfma_f32_16x16x32_bf16 v[112:115], a[144:147], a[152:155], v[112:115]
    ds_read_b128 a[192:195], v21 offset:8192
    s_mul_i32 s45, s57, 229376
    v_mfma_f32_16x16x32_bf16 v[116:119], a[148:151], a[152:155], v[116:119]
    ds_read_b128 a[180:183], v19 offset:18432
    s_add_u32 m0, s48, 49152
    v_mfma_f32_16x16x32_bf16 v[120:123], a[136:139], a[156:159], v[120:123]
    ds_read_b128 a[184:187], v19 offset:20480
    s_add_u32 s45, s45, s56
    s_nop 0
    v_mfma_f32_16x16x32_bf16 v[124:127], a[140:143], a[156:159], v[124:127]
    ds_read_b128 a[188:191], v19 offset:22528
    buffer_load_dwordx4 v10, s[12:15], s45 offen offset:0 lds
    v_mfma_f32_16x16x32_bf16 v[128:131], a[144:147], a[156:159], v[128:131]
    ds_read_b128 a[196:199], v21 offset:12288
    v_mul_f32 v201, 0x41800000, v69
    v_mfma_f32_16x16x32_bf16 v[132:135], a[148:151], a[156:159], v[132:135]
    v_exp_f32 v200, v200
    s_waitcnt lgkmcnt(6)
    v_mfma_f32_16x16x32_bf16 v[136:139], a[160:163], a[136:139], v[136:139]
    buffer_load_dwordx4 v11, s[12:15], s45 offen offset:1024 lds
    v_fract_f32_e64 v201, v201
    v_mfma_f32_16x16x32_bf16 v[140:143], a[160:163], a[140:143], v[140:143]
    ds_read_b64_tr_b16 a[200:201], v22 offset:24576
    v_cos_f32_e64 v32, v201
    v_mfma_f32_16x16x32_bf16 v[144:147], a[160:163], a[144:147], v[144:147]
    ds_read_b64_tr_b16 a[202:203], v22 offset:25600
    v_sin_f32_e64 v33, v201
    v_mfma_f32_16x16x32_bf16 v[148:151], a[160:163], a[148:151], v[148:151]
    ds_read_b64_tr_b16 a[204:205], v23 offset:24576
    s_nop 0
    v_mfma_f32_16x16x32_bf16 v[152:155], a[164:167], a[136:139], v[152:155]
    ds_read_b64_tr_b16 a[206:207], v23 offset:25600
    buffer_load_dwordx4 v12, s[12:15], s45 offen offset:2048 lds
    v_mfma_f32_16x16x32_bf16 v[156:159], a[164:167], a[140:143], v[156:159]
    ds_read_b64_tr_b16 a[208:209], v24 offset:24576
    v_mul_f32 v32, v32, v200
    v_mfma_f32_16x16x32_bf16 v[160:163], a[164:167], a[144:147], v[160:163]
    ds_read_b64_tr_b16 a[210:211], v24 offset:25600
    v_mul_f32_e64 v33, v33, v200
    v_mfma_f32_16x16x32_bf16 v[164:167], a[164:167], a[148:151], v[164:167]
    v_mul_f32 v200, 0x44800000, v68
    v_mul_f32 v201, 0x44800000, v69
    v_mfma_f32_16x16x32_bf16 v[168:171], a[168:171], a[136:139], v[168:171]
    buffer_load_dwordx4 v13, s[12:15], s45 offen offset:3072 lds
    s_add_u32 s57, s57, 1
    v_mfma_f32_16x16x32_bf16 v[172:175], a[168:171], a[140:143], v[172:175]
    s_and_b32 s57, s57, 7
    v_exp_f32 v200, v200
    v_mfma_f32_16x16x32_bf16 v[176:179], a[168:171], a[144:147], v[176:179]
    v_fract_f32 v201, v201
    v_cos_f32_e64 v38, v201
    v_mfma_f32_16x16x32_bf16 v[180:183], a[168:171], a[148:151], v[180:183]
    s_cbranch_vccnz L_sk2
    s_waitcnt lgkmcnt(12)
    v_mfma_f32_16x16x32_bf16 v[184:187], a[172:175], a[136:139], v[184:187]
    ds_read_b64_tr_b16 a[212:213], v25 offset:24576
    v_mfma_f32_16x16x32_bf16 v[188:191], a[172:175], a[140:143], v[188:191]
    ds_read_b64_tr_b16 a[214:215], v25 offset:25600
    v_mfma_f32_16x16x32_bf16 v[192:195], a[172:175], a[144:147], v[192:195]
    v_mfma_f32_16x16x32_bf16 v[196:199], a[172:175], a[148:151], v[196:199]
L_sk2:
    s_waitcnt lgkmcnt(6)
    v_mfma_f32_16x16x32_bf16 v[104:107], a[176:179], a[192:195], v[104:107]
    s_waitcnt vmcnt(10)
    s_barrier
    s_mov_b64 exec, 0xf
    buffer_load_dword a227, v89, s[28:31], 0 offen
    s_mov_b64 exec, -1
    s_nop 0
    v_mfma_f32_16x16x32_bf16 v[108:111], a[180:183], a[192:195], v[108:111]
    ds_read_b128 a[136:139], v18 offset:32768
    s_lshl_b32 s44, s57, 7
    v_mfma_f32_16x16x32_bf16 v[112:115], a[184:187], a[192:195], v[112:115]
    ds_read_b128 a[152:155], v20 offset:16384
    s_add_u32 m0, s46, 0
    v_mfma_f32_16x16x32_bf16 v[116:119], a[188:191], a[192:195], v[116:119]
    ds_read_b128 a[140:143], v18 offset:34816
    s_add_u32 s43, s54, s44
    v_mfma_f32_16x16x32_bf16 v[120:123], a[176:179], a[196:199], v[120:123]
    ds_read_b128 a[144:147], v18 offset:36864
    buffer_load_dwordx4 v2, s[4:7], s43 offen offset:0 lds
    v_mfma_f32_16x16x32_bf16 v[124:127], a[180:183], a[196:199], v[124:127]
    ds_read_b128 a[148:151], v18 offset:38912
    v_sin_f32 v39, v201
    v_mfma_f32_16x16x32_bf16 v[128:131], a[184:187], a[196:199], v[128:131]
    ds_read_b128 a[156:159], v20 offset:20480
    buffer_load_dwordx4 v3, s[4:7], s43 offen offset:1024 lds
    v_mfma_f32_16x16x32_bf16 v[132:135], a[188:191], a[196:199], v[132:135]
    s_nop 0
    s_waitcnt lgkmcnt(6)
    v_mfma_f32_16x16x32_bf16 v[136:139], a[200:203], a[176:179], v[136:139]
    v_mul_f32 v38, v38, v200
    v_mul_f32 v39, v39, v200
    v_mfma_f32_16x16x32_bf16 v[140:143], a[200:203], a[180:183], v[140:143]
    ds_read_b64_tr_b16 a[160:161], v22 offset:32768
    v_mul_f32 v202, 0x41800000, v203
    v_mfma_f32_16x16x32_bf16 v[144:147], a[200:203], a[184:187], v[144:147]
    ds_read_b64_tr_b16 a[162:163], v22 offset:33792
    buffer_load_dwordx4 v4, s[4:7], s43 offen offset:2048 lds
    v_mfma_f32_16x16x32_bf16 v[148:151], a[200:203], a[188:191], v[148:151]
    ds_read_b64_tr_b16 a[164:165], v23 offset:32768
    v_mul_f32_e64 v200, v202, v68
    v_mfma_f32_16x16x32_bf16 v[152:155], a[204:207], a[176:179], v[152:155]
    ds_read_b64_tr_b16 a[166:167], v23 offset:33792
    v_mul_f32_e64 v201, v202, v69
    v_mfma_f32_16x16x32_bf16 v[156:159], a[204:207], a[180:183], v[156:159]
    ds_read_b64_tr_b16 a[168:169], v24 offset:32768
    buffer_load_dwordx4 v5, s[4:7], s43 offen offset:3072 lds
    v_mfma_f32_16x16x32_bf16 v[160:163], a[204:207], a[184:187], v[160:163]
    ds_read_b64_tr_b16 a[170:171], v24 offset:33792
    s_add_u32 m0, s47, 0
    v_mfma_f32_16x16x32_bf16 v[164:167], a[204:207], a[188:191], v[164:167]
    s_add_u32 s44, s55, s44
    v_exp_f32 v200, v200
    v_mfma_f32_16x16x32_bf16 v[168:171], a[208:211], a[176:179], v[168:171]
    v_fract_f32 v201, v201
    v_cos_f32_e64 v34, v201
    v_mfma_f32_16x16x32_bf16 v[172:175], a[208:211], a[180:183], v[172:175]
    buffer_load_dwordx4 v6, s[8:11], s44 offen offset:0 lds
    v_sin_f32 v35, v201
    v_mfma_f32_16x16x32_bf16 v[176:179], a[208:211], a[184:187], v[176:179]
    s_nop 0
    v_mul_f32_e64 v34, v34, v200
    v_mfma_f32_16x16x32_bf16 v[180:183], a[208:211], a[188:191], v[180:183]
    s_cbranch_vccnz L_sk3
    s_waitcnt lgkmcnt(12)
    v_mfma_f32_16x16x32_bf16 v[184:187], a[212:215], a[176:179], v[184:187]
    ds_read_b64_tr_b16 a[172:173], v25 offset:32768
    v_mfma_f32_16x16x32_bf16 v[188:191], a[212:215], a[180:183], v[188:191]
    ds_read_b64_tr_b16 a[174:175], v25 offset:33792
    v_mfma_f32_16x16x32_bf16 v[192:195], a[212:215], a[184:187], v[192:195]
    v_mfma_f32_16x16x32_bf16 v[196:199], a[212:215], a[188:191], v[196:199]
L_sk3:
    s_waitcnt lgkmcnt(6)
    v_mfma_f32_16x16x32_bf16 v[104:107], a[136:139], a[152:155], v[104:107]
    v_mul_f32 v35, v35, v200
    v_mul_f32 v202, 0x43000000, v203
    v_mfma_f32_16x16x32_bf16 v[108:111], a[140:143], a[152:155], v[108:111]
    ds_read_b128 a[176:179], v19 offset:32768
    buffer_load_dwordx4 v7, s[8:11], s44 offen offset:1024 lds
    v_mfma_f32_16x16x32_bf16 v[112:115], a[144:147], a[152:155], v[112:115]
    ds_read_b128 a[192:195], v21 offset:16384
    s_mul_i32 s45, s57, 229376
    v_mfma_f32_16x16x32_bf16 v[116:119], a[148:151], a[152:155], v[116:119]
    ds_read_b128 a[180:183], v19 offset:34816
    s_add_u32 m0, s48, 0
    v_mfma_f32_16x16x32_bf16 v[120:123], a[136:139], a[156:159], v[120:123]
    ds_read_b128 a[184:187], v19 offset:36864
    s_add_u32 s45, s45, s56
    v_mfma_f32_16x16x32_bf16 v[124:127], a[140:143], a[156:159], v[124:127]
    ds_read_b128 a[188:191], v19 offset:38912
    buffer_load_dwordx4 v10, s[12:15], s45 offen offset:0 lds
    v_mfma_f32_16x16x32_bf16 v[128:131], a[144:147], a[156:159], v[128:131]
    ds_read_b128 a[196:199], v21 offset:20480
    v_mul_f32 v200, v202, v68
    v_mfma_f32_16x16x32_bf16 v[132:135], a[148:151], a[156:159], v[132:135]
    v_mul_f32_e64 v201, v202, v69
    s_waitcnt lgkmcnt(6)
    v_mfma_f32_16x16x32_bf16 v[136:139], a[160:163], a[136:139], v[136:139]
    buffer_load_dwordx4 v11, s[12:15], s45 offen offset:1024 lds
    v_exp_f32_e64 v200, v200
    v_mfma_f32_16x16x32_bf16 v[140:143], a[160:163], a[140:143], v[140:143]
    ds_read_b64_tr_b16 a[200:201], v22 offset:40960
    v_fract_f32_e64 v201, v201
    v_mfma_f32_16x16x32_bf16 v[144:147], a[160:163], a[144:147], v[144:147]
    ds_read_b64_tr_b16 a[202:203], v22 offset:41984
    v_cos_f32_e64 v36, v201
    v_mfma_f32_16x16x32_bf16 v[148:151], a[160:163], a[148:151], v[148:151]
    ds_read_b64_tr_b16 a[204:205], v23 offset:40960
    v_sin_f32_e64 v37, v201
    v_mfma_f32_16x16x32_bf16 v[152:155], a[164:167], a[136:139], v[152:155]
    ds_read_b64_tr_b16 a[206:207], v23 offset:41984
    buffer_load_dwordx4 v12, s[12:15], s45 offen offset:2048 lds
    v_mfma_f32_16x16x32_bf16 v[156:159], a[164:167], a[140:143], v[156:159]
    ds_read_b64_tr_b16 a[208:209], v24 offset:40960
    s_nop 0
    v_mfma_f32_16x16x32_bf16 v[160:163], a[164:167], a[144:147], v[160:163]
    ds_read_b64_tr_b16 a[210:211], v24 offset:41984
    v_mul_f32 v36, v36, v200
    v_mfma_f32_16x16x32_bf16 v[164:167], a[164:167], a[148:151], v[164:167]
    v_mul_f32 v37, v37, v200
    v_mul_f32 v200, v52, v52
    v_mfma_f32_16x16x32_bf16 v[168:171], a[168:171], a[136:139], v[168:171]
    buffer_load_dwordx4 v13, s[12:15], s45 offen offset:3072 lds
    s_add_u32 s57, s57, 1
    v_mfma_f32_16x16x32_bf16 v[172:175], a[168:171], a[140:143], v[172:175]
    s_and_b32 s57, s57, 7
    v_fma_f32 v200, v53, v53, v200
    v_mfma_f32_16x16x32_bf16 v[176:179], a[168:171], a[144:147], v[176:179]
    v_rcp_f32_e64 v200, v200
    v_mfma_f32_16x16x32_bf16 v[180:183], a[168:171], a[148:151], v[180:183]
    s_cbranch_vccnz L_sk4
    s_waitcnt lgkmcnt(12)
    v_mfma_f32_16x16x32_bf16 v[184:187], a[172:175], a[136:139], v[184:187]
    ds_read_b64_tr_b16 a[212:213], v25 offset:40960
    v_mfma_f32_16x16x32_bf16 v[188:191], a[172:175], a[140:143], v[188:191]
    ds_read_b64_tr_b16 a[214:215], v25 offset:41984
    v_mfma_f32_16x16x32_bf16 v[192:195], a[172:175], a[144:147], v[192:195]
    v_mfma_f32_16x16x32_bf16 v[196:199], a[172:175], a[148:151], v[196:199]
L_sk4:
    s_waitcnt lgkmcnt(6)
    v_mfma_f32_16x16x32_bf16 v[104:107], a[176:179], a[192:195], v[104:107]
    s_waitcnt vmcnt(11)
    s_barrier
    v_mfma_f32_16x16x32_bf16 v[108:111], a[180:183], a[192:195], v[108:111]
    ds_read_b128 a[136:139], v18 offset:49152
    s_lshl_b32 s44, s57, 7
    v_mfma_f32_16x16x32_bf16 v[112:115], a[184:187], a[192:195], v[112:115]
    ds_read_b128 a[152:155], v20 offset:24576
    s_add_u32 m0, s46, 16384
    v_mfma_f32_16x16x32_bf16 v[116:119], a[188:191], a[192:195], v[116:119]
    ds_read_b128 a[140:143], v18 offset:51200
    s_add_u32 s43, s54, s44
    v_mfma_f32_16x16x32_bf16 v[120:123], a[176:179], a[196:199], v[120:123]
    ds_read_b128 a[144:147], v18 offset:53248
    buffer_load_dwordx4 v2, s[4:7], s43 offen offset:0 lds
    v_mfma_f32_16x16x32_bf16 v[124:127], a[180:183], a[196:199], v[124:127]
    ds_read_b128 a[148:151], v18 offset:55296
    v_add_f32 v201, -1.0, v30
    v_mfma_f32_16x16x32_bf16 v[128:131], a[184:187], a[196:199], v[128:131]
    ds_read_b128 a[156:159], v20 offset:28672
    buffer_load_dwordx4 v3, s[4:7], s43 offen offset:1024 lds
    v_mfma_f32_16x16x32_bf16 v[132:135], a[188:191], a[196:199], v[132:135]
    v_mul_f32 v40, v201, v52
    s_waitcnt lgkmcnt(6)
    v_mfma_f32_16x16x32_bf16 v[136:139], a[200:203], a[176:179], v[136:139]
    v_fma_f32 v40, v31, v53, v40
    v_mul_f32_e64 v41, v31, v52
    v_mfma_f32_16x16x32_bf16 v[140:143], a[200:203], a[180:183], v[140:143]
    ds_read_b64_tr_b16 a[160:161], v22 offset:49152
    v_fma_f32 v41, -v201, v53, v41
    v_mfma_f32_16x16x32_bf16 v[144:147], a[200:203], a[184:187], v[144:147]
    ds_read_b64_tr_b16 a[162:163], v22 offset:50176
    buffer_load_dwordx4 v4, s[4:7], s43 offen offset:2048 lds
    v_mfma_f32_16x16x32_bf16 v[148:151], a[200:203], a[188:191], v[148:151]
    ds_read_b64_tr_b16 a[164:165], v23 offset:49152
    v_add_f32_e64 v200, v200, v200
    v_mfma_f32_16x16x32_bf16 v[152:155], a[204:207], a[176:179], v[152:155]
    ds_read_b64_tr_b16 a[166:167], v23 offset:50176
    v_mul_f32_e64 v40, v40, v200
    v_mfma_f32_16x16x32_bf16 v[156:159], a[204:207], a[180:183], v[156:159]
    ds_read_b64_tr_b16 a[168:169], v24 offset:49152
    buffer_load_dwordx4 v5, s[4:7], s43 offen offset:3072 lds
    v_mfma_f32_16x16x32_bf16 v[160:163], a[204:207], a[184:187], v[160:163]
    ds_read_b64_tr_b16 a[170:171], v24 offset:50176
    s_add_u32 m0, s47, 8192
    v_mfma_f32_16x16x32_bf16 v[164:167], a[204:207], a[188:191], v[164:167]
    s_add_u32 s44, s55, s44
    v_mul_f32_e64 v41, v41, v200
    v_mfma_f32_16x16x32_bf16 v[168:171], a[208:211], a[176:179], v[168:171]
    s_lshl_b32 s49, s99, 12
    s_add_u32 s49, s49, 139264
    v_mfma_f32_16x16x32_bf16 v[172:175], a[208:211], a[180:183], v[172:175]
    buffer_load_dwordx4 v6, s[8:11], s44 offen offset:0 lds
    s_lshl_b32 s50, s100, 11
    v_mfma_f32_16x16x32_bf16 v[176:179], a[208:211], a[184:187], v[176:179]
    s_add_u32 s50, s50, s49
    v_bfe_u32 v200, v1, 1, 1
    v_mfma_f32_16x16x32_bf16 v[180:183], a[208:211], a[188:191], v[180:183]
    s_cbranch_vccnz L_sk5
    s_waitcnt lgkmcnt(12)
    v_mfma_f32_16x16x32_bf16 v[184:187], a[212:215], a[176:179], v[184:187]
    ds_read_b64_tr_b16 a[172:173], v25 offset:49152
    v_mfma_f32_16x16x32_bf16 v[188:191], a[212:215], a[180:183], v[188:191]
    ds_read_b64_tr_b16 a[174:175], v25 offset:50176
    v_mfma_f32_16x16x32_bf16 v[192:195], a[212:215], a[184:187], v[192:195]
    v_mfma_f32_16x16x32_bf16 v[196:199], a[212:215], a[188:191], v[196:199]
L_sk5:
    s_waitcnt lgkmcnt(6)
    v_mfma_f32_16x16x32_bf16 v[104:107], a[136:139], a[152:155], v[104:107]
    v_and_b32 v201, 1, v1
    v_lshl_add_u32 v200, v201, 1, v200
    v_mfma_f32_16x16x32_bf16 v[108:111], a[140:143], a[152:155], v[108:111]
    ds_read_b128 a[176:179], v19 offset:49152
    buffer_load_dwordx4 v7, s[8:11], s44 offen offset:1024 lds
    v_mfma_f32_16x16x32_bf16 v[112:115], a[144:147], a[152:155], v[112:115]
    ds_read_b128 a[192:195], v21 offset:24576
    s_mul_i32 s45, s57, 229376
    v_mfma_f32_16x16x32_bf16 v[116:119], a[148:151], a[152:155], v[116:119]
    ds_read_b128 a[180:183], v19 offset:51200
    s_add_u32 m0, s48, 16384
    v_mfma_f32_16x16x32_bf16 v[120:123], a[136:139], a[156:159], v[120:123]
    ds_read_b128 a[184:187], v19 offset:53248
    s_add_u32 s45, s45, s56
    v_mfma_f32_16x16x32_bf16 v[124:127], a[140:143], a[156:159], v[124:127]
    ds_read_b128 a[188:191], v19 offset:55296
    buffer_load_dwordx4 v10, s[12:15], s45 offen offset:0 lds
    v_mfma_f32_16x16x32_bf16 v[128:131], a[144:147], a[156:159], v[128:131]
    ds_read_b128 a[196:199], v21 offset:28672
    v_and_b32 v201, 4, v1
    v_mfma_f32_16x16x32_bf16 v[132:135], a[148:151], a[156:159], v[132:135]
    v_or_b32 v200, v200, v201
    s_waitcnt lgkmcnt(6)
    v_mfma_f32_16x16x32_bf16 v[136:139], a[160:163], a[136:139], v[136:139]
    buffer_load_dwordx4 v11, s[12:15], s45 offen offset:1024 lds
    v_lshrrev_b32_e64 v201, 4, v1
    v_mfma_f32_16x16x32_bf16 v[140:143], a[160:163], a[140:143], v[140:143]
    ds_read_b64_tr_b16 a[200:201], v22 offset:57344
    v_lshlrev_b32_e64 v201, 1, v201
    v_mfma_f32_16x16x32_bf16 v[144:147], a[160:163], a[144:147], v[144:147]
    ds_read_b64_tr_b16 a[202:203], v22 offset:58368
    v_xor_b32_e64 v200, v200, v201
    v_mfma_f32_16x16x32_bf16 v[148:151], a[160:163], a[148:151], v[148:151]
    ds_read_b64_tr_b16 a[204:205], v23 offset:57344
    v_lshlrev_b32_e64 v200, 4, v200
    v_mfma_f32_16x16x32_bf16 v[152:155], a[164:167], a[136:139], v[152:155]
    ds_read_b64_tr_b16 a[206:207], v23 offset:58368
    buffer_load_dwordx4 v12, s[12:15], s45 offen offset:2048 lds
    v_mfma_f32_16x16x32_bf16 v[156:159], a[164:167], a[140:143], v[156:159]
    ds_read_b64_tr_b16 a[208:209], v24 offset:57344
    v_and_b32_e64 v201, 15, v1
    v_mfma_f32_16x16x32_bf16 v[160:163], a[164:167], a[144:147], v[160:163]
    ds_read_b64_tr_b16 a[210:211], v24 offset:58368
    v_lshl_add_u32 v200, v201, 7, v200
    v_mfma_f32_16x16x32_bf16 v[164:167], a[164:167], a[148:151], v[164:167]
    v_add_u32_e64 v200, s50, v200
    v_accvgpr_write_b32 a216, v200
    v_mfma_f32_16x16x32_bf16 v[168:171], a[168:171], a[136:139], v[168:171]
    buffer_load_dwordx4 v13, s[12:15], s45 offen offset:3072 lds
    s_add_u32 s57, s57, 1
    v_mfma_f32_16x16x32_bf16 v[172:175], a[168:171], a[140:143], v[172:175]
    s_and_b32 s57, s57, 7
    v_lshrrev_b32 v202, 5, v1
    v_mfma_f32_16x16x32_bf16 v[176:179], a[168:171], a[144:147], v[176:179]
    v_and_b32 v200, 31, v1
    v_lshlrev_b32_e64 v200, 1, v200
    v_mfma_f32_16x16x32_bf16 v[180:183], a[168:171], a[148:151], v[180:183]
    s_cbranch_vccnz L_sk6
    s_waitcnt lgkmcnt(12)
    v_mfma_f32_16x16x32_bf16 v[184:187], a[172:175], a[136:139], v[184:187]
    ds_read_b64_tr_b16 a[212:213], v25 offset:57344
    v_mfma_f32_16x16x32_bf16 v[188:191], a[172:175], a[140:143], v[188:191]
    ds_read_b64_tr_b16 a[214:215], v25 offset:58368
    v_mfma_f32_16x16x32_bf16 v[192:195], a[172:175], a[144:147], v[192:195]
    v_mfma_f32_16x16x32_bf16 v[196:199], a[172:175], a[148:151], v[196:199]
L_sk6:
    s_waitcnt lgkmcnt(6)
    v_mfma_f32_16x16x32_bf16 v[104:107], a[176:179], a[192:195], v[104:107]
    s_waitcnt vmcnt(10)
    s_barrier
    v_mfma_f32_16x16x32_bf16 v[108:111], a[180:183], a[192:195], v[108:111]
    ds_read_b128 a[136:139], v18 offset:0
    s_lshl_b32 s44, s57, 7
    v_mfma_f32_16x16x32_bf16 v[112:115], a[184:187], a[192:195], v[112:115]
    ds_read_b128 a[152:155], v20 offset:0
    s_add_u32 m0, s46, 32768
    v_mfma_f32_16x16x32_bf16 v[116:119], a[188:191], a[192:195], v[116:119]
    ds_read_b128 a[140:143], v18 offset:2048
    s_add_u32 s43, s54, s44
    s_nop 0
    v_mfma_f32_16x16x32_bf16 v[120:123], a[176:179], a[196:199], v[120:123]
    ds_read_b128 a[144:147], v18 offset:4096
    buffer_load_dwordx4 v2, s[4:7], s43 offen offset:0 lds
    v_mfma_f32_16x16x32_bf16 v[124:127], a[180:183], a[196:199], v[124:127]
    ds_read_b128 a[148:151], v18 offset:6144
    v_lshl_add_u32 v201, v202, 10, v200
    v_mfma_f32_16x16x32_bf16 v[128:131], a[184:187], a[196:199], v[128:131]
    ds_read_b128 a[156:159], v20 offset:4096
    buffer_load_dwordx4 v3, s[4:7], s43 offen offset:1024 lds
    v_mfma_f32_16x16x32_bf16 v[132:135], a[188:191], a[196:199], v[132:135]
    v_add_u32 v201, s47, v201
    s_waitcnt lgkmcnt(6)
    v_mfma_f32_16x16x32_bf16 v[136:139], a[200:203], a[176:179], v[136:139]
    v_accvgpr_write_b32 a218, v201
    v_lshl_add_u32 v200, v202, 14, v200
    v_mfma_f32_16x16x32_bf16 v[140:143], a[200:203], a[180:183], v[140:143]
    ds_read_b64_tr_b16 a[160:161], v22 offset:0
    v_add_u32_e64 v200, s69, v200
    v_mfma_f32_16x16x32_bf16 v[144:147], a[200:203], a[184:187], v[144:147]
    ds_read_b64_tr_b16 a[162:163], v22 offset:1024
    buffer_load_dwordx4 v4, s[4:7], s43 offen offset:2048 lds
    v_mfma_f32_16x16x32_bf16 v[148:151], a[200:203], a[188:191], v[148:151]
    ds_read_b64_tr_b16 a[164:165], v23 offset:0
    v_lshlrev_b32_e64 v200, 1, v200
    v_mfma_f32_16x16x32_bf16 v[152:155], a[204:207], a[176:179], v[152:155]
    ds_read_b64_tr_b16 a[166:167], v23 offset:1024
    v_accvgpr_write_b32 a221, v200
    v_mfma_f32_16x16x32_bf16 v[156:159], a[204:207], a[180:183], v[156:159]
    ds_read_b64_tr_b16 a[168:169], v24 offset:0
    buffer_load_dwordx4 v5, s[4:7], s43 offen offset:3072 lds
    v_mfma_f32_16x16x32_bf16 v[160:163], a[204:207], a[184:187], v[160:163]
    ds_read_b64_tr_b16 a[170:171], v24 offset:1024
    s_add_u32 m0, s47, 16384
    v_mfma_f32_16x16x32_bf16 v[164:167], a[204:207], a[188:191], v[164:167]
    s_add_u32 s44, s55, s44
    v_bfe_u32 v200, v1, 2, 2
    v_mfma_f32_16x16x32_bf16 v[168:171], a[208:211], a[176:179], v[168:171]
    v_lshl_add_u32 v202, v202, 3, v200
    v_lshrrev_b32 v201, 1, v200
    v_mfma_f32_16x16x32_bf16 v[172:175], a[208:211], a[180:183], v[172:175]
    buffer_load_dwordx4 v6, s[8:11], s44 offen offset:0 lds
    v_and_b32_e64 v200, 1, v200
    v_mfma_f32_16x16x32_bf16 v[176:179], a[208:211], a[184:187], v[176:179]
    v_lshl_add_u32 v200, v200, 1, v201
    v_and_b32_e64 v201, 3, v1
    v_mfma_f32_16x16x32_bf16 v[180:183], a[208:211], a[188:191], v[180:183]
    s_cbranch_vccnz L_sk7
    s_waitcnt lgkmcnt(12)
    v_mfma_f32_16x16x32_bf16 v[184:187], a[212:215], a[176:179], v[184:187]
    ds_read_b64_tr_b16 a[172:173], v25 offset:0
    v_mfma_f32_16x16x32_bf16 v[188:191], a[212:215], a[180:183], v[188:191]
    ds_read_b64_tr_b16 a[174:175], v25 offset:1024
    v_mfma_f32_16x16x32_bf16 v[192:195], a[212:215], a[184:187], v[192:195]
    v_mfma_f32_16x16x32_bf16 v[196:199], a[212:215], a[188:191], v[196:199]
L_sk7:
    s_waitcnt lgkmcnt(6)
    v_mfma_f32_16x16x32_bf16 v[104:107], a[136:139], a[152:155], v[104:107]
    v_lshlrev_b32 v201, 1, v201
    v_add_u32_e64 v201, s100, v201
    v_mfma_f32_16x16x32_bf16 v[108:111], a[140:143], a[152:155], v[108:111]
    ds_read_b128 a[176:179], v19 offset:0
    buffer_load_dwordx4 v7, s[8:11], s44 offen offset:1024 lds
    v_mfma_f32_16x16x32_bf16 v[112:115], a[144:147], a[152:155], v[112:115]
    ds_read_b128 a[192:195], v21 offset:0
    s_mul_i32 s45, s57, 229376
    v_mfma_f32_16x16x32_bf16 v[116:119], a[148:151], a[152:155], v[116:119]
    ds_read_b128 a[180:183], v19 offset:2048
    s_add_u32 m0, s48, 32768
    v_mfma_f32_16x16x32_bf16 v[120:123], a[136:139], a[156:159], v[120:123]
    ds_read_b128 a[184:187], v19 offset:4096
    s_add_u32 s45, s45, s56
    v_mfma_f32_16x16x32_bf16 v[124:127], a[140:143], a[156:159], v[124:127]
    ds_read_b128 a[188:191], v19 offset:6144
    buffer_load_dwordx4 v10, s[12:15], s45 offen offset:0 lds
    v_mfma_f32_16x16x32_bf16 v[128:131], a[144:147], a[156:159], v[128:131]
    ds_read_b128 a[196:199], v21 offset:4096
    v_xor_b32 v201, v201, v200
    v_mfma_f32_16x16x32_bf16 v[132:135], a[148:151], a[156:159], v[132:135]
    v_lshlrev_b32 v201, 4, v201
    s_waitcnt lgkmcnt(6)
    v_mfma_f32_16x16x32_bf16 v[136:139], a[160:163], a[136:139], v[136:139]
    buffer_load_dwordx4 v11, s[12:15], s45 offen offset:1024 lds
    v_lshl_add_u32 v201, v202, 7, v201
    v_mfma_f32_16x16x32_bf16 v[140:143], a[160:163], a[140:143], v[140:143]
    ds_read_b64_tr_b16 a[200:201], v22 offset:8192
    v_bfe_u32 v203, v1, 4, 1
    v_mfma_f32_16x16x32_bf16 v[144:147], a[160:163], a[144:147], v[144:147]
    ds_read_b64_tr_b16 a[202:203], v22 offset:9216
    v_lshl_add_u32 v201, v203, 3, v201
    v_mfma_f32_16x16x32_bf16 v[148:151], a[160:163], a[148:151], v[148:151]
    ds_read_b64_tr_b16 a[204:205], v23 offset:8192
    v_add_u32_e64 v201, s49, v201
    v_mfma_f32_16x16x32_bf16 v[152:155], a[164:167], a[136:139], v[152:155]
    ds_read_b64_tr_b16 a[206:207], v23 offset:9216
    buffer_load_dwordx4 v12, s[12:15], s45 offen offset:2048 lds
    v_mfma_f32_16x16x32_bf16 v[156:159], a[164:167], a[140:143], v[156:159]
    ds_read_b64_tr_b16 a[208:209], v24 offset:8192
    v_accvgpr_write_b32 a217, v201
    v_mfma_f32_16x16x32_bf16 v[160:163], a[164:167], a[144:147], v[160:163]
    ds_read_b64_tr_b16 a[210:211], v24 offset:9216
    v_and_b32_e64 v200, 3, v1
    v_mfma_f32_16x16x32_bf16 v[164:167], a[164:167], a[148:151], v[164:167]
    v_lshl_add_u32 v28, v200, 2, s71
    s_lshl_b32 s49, s37, 4
    v_mfma_f32_16x16x32_bf16 v[168:171], a[168:171], a[136:139], v[168:171]
    buffer_load_dwordx4 v13, s[12:15], s45 offen offset:3072 lds
    s_add_u32 s57, s57, 1
    v_mfma_f32_16x16x32_bf16 v[172:175], a[168:171], a[140:143], v[172:175]
    s_and_b32 s57, s57, 7
    s_add_u32 s49, s49, s40
    v_mfma_f32_16x16x32_bf16 v[176:179], a[168:171], a[144:147], v[176:179]
    s_lshl_b32 s49, s49, 2
    s_add_u32 s49, s49, s36
    v_mfma_f32_16x16x32_bf16 v[180:183], a[168:171], a[148:151], v[180:183]
    s_cbranch_vccnz L_sk8
    s_waitcnt lgkmcnt(12)
    v_mfma_f32_16x16x32_bf16 v[184:187], a[172:175], a[136:139], v[184:187]
    ds_read_b64_tr_b16 a[212:213], v25 offset:8192
    v_mfma_f32_16x16x32_bf16 v[188:191], a[172:175], a[140:143], v[188:191]
    ds_read_b64_tr_b16 a[214:215], v25 offset:9216
    v_mfma_f32_16x16x32_bf16 v[192:195], a[172:175], a[144:147], v[192:195]
    v_mfma_f32_16x16x32_bf16 v[196:199], a[172:175], a[148:151], v[196:199]
L_sk8:
    s_waitcnt lgkmcnt(6)
    v_mfma_f32_16x16x32_bf16 v[104:107], a[176:179], a[192:195], v[104:107]
    s_waitcnt vmcnt(10)
    s_barrier
    v_mfma_f32_16x16x32_bf16 v[108:111], a[180:183], a[192:195], v[108:111]
    ds_read_b128 a[136:139], v18 offset:16384
    s_lshl_b32 s44, s57, 7
    v_mfma_f32_16x16x32_bf16 v[112:115], a[184:187], a[192:195], v[112:115]
    ds_read_b128 a[152:155], v20 offset:8192
    s_add_u32 m0, s46, 49152
    v_mfma_f32_16x16x32_bf16 v[116:119], a[188:191], a[192:195], v[116:119]
    ds_read_b128 a[140:143], v18 offset:18432
    s_add_u32 s43, s54, s44
    s_nop 0
    v_mfma_f32_16x16x32_bf16 v[120:123], a[176:179], a[196:199], v[120:123]
    ds_read_b128 a[144:147], v18 offset:20480
    buffer_load_dwordx4 v2, s[4:7], s43 offen offset:0 lds
    v_mfma_f32_16x16x32_bf16 v[124:127], a[180:183], a[196:199], v[124:127]
    ds_read_b128 a[148:151], v18 offset:22528
    buffer_load_dwordx4 v3, s[4:7], s43 offen offset:1024 lds
    v_mfma_f32_16x16x32_bf16 v[128:131], a[184:187], a[196:199], v[128:131]
    ds_read_b128 a[156:159], v20 offset:12288
    s_add_u32 s50, s39, 1
    v_mfma_f32_16x16x32_bf16 v[132:135], a[188:191], a[196:199], v[132:135]
    s_and_b32 s50, s50, 3
    s_waitcnt lgkmcnt(6)
    v_mfma_f32_16x16x32_bf16 v[136:139], a[200:203], a[176:179], v[136:139]
    buffer_load_dwordx4 v4, s[4:7], s43 offen offset:2048 lds
    s_lshl_b32 s50, s50, 4
    v_mfma_f32_16x16x32_bf16 v[140:143], a[200:203], a[180:183], v[140:143]
    ds_read_b64_tr_b16 a[160:161], v22 offset:16384
    s_add_u32 s50, s50, s49
    s_nop 0
    v_mfma_f32_16x16x32_bf16 v[144:147], a[200:203], a[184:187], v[144:147]
    ds_read_b64_tr_b16 a[162:163], v22 offset:17408
    s_mul_i32 s72, s50, 6144
    s_branch L_pg2
.p2align 12
L_pad2:
    s_branch L_touch_ret
    s_nop 0
L_pg2:
    v_mfma_f32_16x16x32_bf16 v[148:151], a[200:203], a[188:191], v[148:151]
    ds_read_b64_tr_b16 a[164:165], v23 offset:16384
    buffer_load_dwordx4 v5, s[4:7], s43 offen offset:3072 lds
    v_mfma_f32_16x16x32_bf16 v[152:155], a[204:207], a[176:179], v[152:155]
    ds_read_b64_tr_b16 a[166:167], v23 offset:17408
    s_add_u32 m0, s47, 24576
    v_mfma_f32_16x16x32_bf16 v[156:159], a[204:207], a[180:183], v[156:159]
    ds_read_b64_tr_b16 a[168:169], v24 offset:16384
    s_add_u32 s44, s55, s44
    v_mfma_f32_16x16x32_bf16 v[160:163], a[204:207], a[184:187], v[160:163]
    ds_read_b64_tr_b16 a[170:171], v24 offset:17408
    buffer_load_dwordx4 v6, s[8:11], s44 offen offset:0 lds
    v_mfma_f32_16x16x32_bf16 v[164:167], a[204:207], a[188:191], v[164:167]
    s_add_u32 s72, s72, 11927552
    s_add_u32 s50, s39, 2
    v_mfma_f32_16x16x32_bf16 v[168:171], a[208:211], a[176:179], v[168:171]
    s_and_b32 s50, s50, 3
    s_lshl_b32 s50, s50, 4
    v_mfma_f32_16x16x32_bf16 v[172:175], a[208:211], a[180:183], v[172:175]
    buffer_load_dwordx4 v7, s[8:11], s44 offen offset:1024 lds
    s_mul_i32 s45, s57, 229376
    v_mfma_f32_16x16x32_bf16 v[176:179], a[208:211], a[184:187], v[176:179]
    s_add_u32 m0, s48, 49152
    s_add_u32 s45, s45, s56
    v_mfma_f32_16x16x32_bf16 v[180:183], a[208:211], a[188:191], v[180:183]
    s_cbranch_vccnz L_sk9
    s_waitcnt lgkmcnt(12)
    v_mfma_f32_16x16x32_bf16 v[184:187], a[212:215], a[176:179], v[184:187]
    ds_read_b64_tr_b16 a[172:173], v25 offset:16384
    v_mfma_f32_16x16x32_bf16 v[188:191], a[212:215], a[180:183], v[188:191]
    ds_read_b64_tr_b16 a[174:175], v25 offset:17408
    v_mfma_f32_16x16x32_bf16 v[192:195], a[212:215], a[184:187], v[192:195]
    v_mfma_f32_16x16x32_bf16 v[196:199], a[212:215], a[188:191], v[196:199]
L_sk9:
    s_waitcnt lgkmcnt(6)
    v_mfma_f32_16x16x32_bf16 v[104:107], a[136:139], a[152:155], v[104:107]
    s_add_u32 s50, s50, s49
    s_nop 0
    s_mul_i32 s73, s50, 6144
    v_mfma_f32_16x16x32_bf16 v[108:111], a[140:143], a[152:155], v[108:111]
    ds_read_b128 a[176:179], v19 offset:16384
    buffer_load_dwordx4 v10, s[12:15], s45 offen offset:0 lds
    v_mfma_f32_16x16x32_bf16 v[112:115], a[144:147], a[152:155], v[112:115]
    ds_read_b128 a[192:195], v21 offset:8192
    s_add_u32 s73, s73, 11929600
    v_mfma_f32_16x16x32_bf16 v[116:119], a[148:151], a[152:155], v[116:119]
    ds_read_b128 a[180:183], v19 offset:18432
    s_add_u32 s50, s39, 3
    v_mfma_f32_16x16x32_bf16 v[120:123], a[136:139], a[156:159], v[120:123]
    ds_read_b128 a[184:187], v19 offset:20480
    buffer_load_dwordx4 v11, s[12:15], s45 offen offset:1024 lds
    v_mfma_f32_16x16x32_bf16 v[124:127], a[140:143], a[156:159], v[124:127]
    ds_read_b128 a[188:191], v19 offset:22528
    s_and_b32 s50, s50, 3
    v_mfma_f32_16x16x32_bf16 v[128:131], a[144:147], a[156:159], v[128:131]
    ds_read_b128 a[196:199], v21 offset:12288
    s_lshl_b32 s50, s50, 4
    v_mfma_f32_16x16x32_bf16 v[132:135], a[148:151], a[156:159], v[132:135]
    buffer_load_dwordx4 v12, s[12:15], s45 offen offset:2048 lds
    s_waitcnt lgkmcnt(6)
    v_mfma_f32_16x16x32_bf16 v[136:139], a[160:163], a[136:139], v[136:139]
    s_add_u32 s50, s50, s49
    s_nop 0
    s_mul_i32 s74, s50, 6144
    v_mfma_f32_16x16x32_bf16 v[140:143], a[160:163], a[140:143], v[140:143]
    ds_read_b64_tr_b16 a[200:201], v22 offset:24576
    s_add_u32 s74, s74, 11931648
    v_mfma_f32_16x16x32_bf16 v[144:147], a[160:163], a[144:147], v[144:147]
    ds_read_b64_tr_b16 a[202:203], v22 offset:25600
    buffer_load_dwordx4 v13, s[12:15], s45 offen offset:3072 lds
    v_mfma_f32_16x16x32_bf16 v[148:151], a[160:163], a[148:151], v[148:151]
    ds_read_b64_tr_b16 a[204:205], v23 offset:24576
    s_add_u32 s57, s57, 1
    v_mfma_f32_16x16x32_bf16 v[152:155], a[164:167], a[136:139], v[152:155]
    ds_read_b64_tr_b16 a[206:207], v23 offset:25600
    s_and_b32 s57, s57, 7
    v_mfma_f32_16x16x32_bf16 v[156:159], a[164:167], a[140:143], v[156:159]
    ds_read_b64_tr_b16 a[208:209], v24 offset:24576
    buffer_load_dword a225, v240, s[16:19], s53 offen
    v_mfma_f32_16x16x32_bf16 v[160:163], a[164:167], a[144:147], v[160:163]
    ds_read_b64_tr_b16 a[210:211], v24 offset:25600
    s_lshl_b32 s50, s39, 4
    v_mfma_f32_16x16x32_bf16 v[164:167], a[164:167], a[148:151], v[164:167]
    s_add_u32 s50, s50, s49
    s_mul_i32 s75, s50, 6144
    v_mfma_f32_16x16x32_bf16 v[168:171], a[168:171], a[136:139], v[168:171]
    buffer_load_dword a226, v241, s[88:91], s70 offen
    s_add_u32 s75, s75, 11927552
    v_mfma_f32_16x16x32_bf16 v[172:175], a[168:171], a[140:143], v[172:175]
    s_lshl_b32 s50, s50, 7
    s_add_u32 s50, s50, 217088
    v_mfma_f32_16x16x32_bf16 v[176:179], a[168:171], a[144:147], v[176:179]
    v_min_u32 v200, 2, v1
    v_lshl_add_u32 v202, v200, 2, s50
    v_mfma_f32_16x16x32_bf16 v[180:183], a[168:171], a[148:151], v[180:183]
    s_cbranch_vccnz L_sk10
    s_waitcnt lgkmcnt(12)
    v_mfma_f32_16x16x32_bf16 v[184:187], a[172:175], a[136:139], v[184:187]
    ds_read_b64_tr_b16 a[212:213], v25 offset:24576
    v_mfma_f32_16x16x32_bf16 v[188:191], a[172:175], a[140:143], v[188:191]
    ds_read_b64_tr_b16 a[214:215], v25 offset:25600
    v_mfma_f32_16x16x32_bf16 v[192:195], a[172:175], a[144:147], v[192:195]
    v_mfma_f32_16x16x32_bf16 v[196:199], a[172:175], a[148:151], v[196:199]
L_sk10:
    s_waitcnt lgkmcnt(6)
    v_mfma_f32_16x16x32_bf16 v[104:107], a[176:179], a[192:195], v[104:107]
    s_waitcnt vmcnt(12)
    s_barrier
    buffer_load_dwordx2 v[86:87], v81, s[28:31], 0 offen sc1
    v_mfma_f32_16x16x32_bf16 v[108:111], a[180:183], a[192:195], v[108:111]
    ds_read_b128 a[136:139], v18 offset:32768
    v_accvgpr_write_b32 a220, v202
    v_mfma_f32_16x16x32_bf16 v[112:115], a[184:187], a[192:195], v[112:115]
    ds_read_b128 a[152:155], v20 offset:16384
    v_add_u32 v201, s39, v200
    v_mfma_f32_16x16x32_bf16 v[116:119], a[188:191], a[192:195], v[116:119]
    ds_read_b128 a[140:143], v18 offset:34816
    v_add_u32_e64 v201, 1, v201
    v_mfma_f32_16x16x32_bf16 v[120:123], a[176:179], a[196:199], v[120:123]
    ds_read_b128 a[144:147], v18 offset:36864
    v_and_b32_e64 v201, 3, v201
    v_mfma_f32_16x16x32_bf16 v[124:127], a[180:183], a[196:199], v[124:127]
    ds_read_b128 a[148:151], v18 offset:38912
    v_lshlrev_b32_e64 v201, 11, v201
    v_mfma_f32_16x16x32_bf16 v[128:131], a[184:187], a[196:199], v[128:131]
    ds_read_b128 a[156:159], v20 offset:20480
    v_lshl_add_u32 v201, v200, 2, v201
    v_mfma_f32_16x16x32_bf16 v[132:135], a[188:191], a[196:199], v[132:135]
    s_lshl_b32 s49, s49, 7
    s_waitcnt lgkmcnt(6)
    v_mfma_f32_16x16x32_bf16 v[136:139], a[200:203], a[176:179], v[136:139]
    s_add_u32 s49, s49, 217088
    v_add_u32_e64 v201, s49, v201
    v_mfma_f32_16x16x32_bf16 v[140:143], a[200:203], a[180:183], v[140:143]
    ds_read_b64_tr_b16 a[160:161], v22 offset:32768
    v_accvgpr_write_b32 a219, v201
    v_mfma_f32_16x16x32_bf16 v[144:147], a[200:203], a[184:187], v[144:147]
    ds_read_b64_tr_b16 a[162:163], v22 offset:33792
    v_lshlrev_b32_e64 v200, 7, v1
    v_mfma_f32_16x16x32_bf16 v[148:151], a[200:203], a[188:191], v[148:151]
    ds_read_b64_tr_b16 a[164:165], v23 offset:32768
    s_lshl_b32 s49, s98, 4
    v_mfma_f32_16x16x32_bf16 v[152:155], a[204:207], a[176:179], v[152:155]
    ds_read_b64_tr_b16 a[166:167], v23 offset:33792
    s_sub_u32 s49, 64, s49
    v_mfma_f32_16x16x32_bf16 v[156:159], a[204:207], a[180:183], v[156:159]
    ds_read_b64_tr_b16 a[168:169], v24 offset:32768
    v_cmp_gt_u32 s[58:59], s49, v1
    v_mfma_f32_16x16x32_bf16 v[160:163], a[204:207], a[184:187], v[160:163]
    ds_read_b64_tr_b16 a[170:171], v24 offset:33792
    v_mov_b32 v203, 0x80000000
    v_mfma_f32_16x16x32_bf16 v[164:167], a[204:207], a[188:191], v[164:167]
    v_bfe_u32 v201, v1, 4, 1
    v_cndmask_b32 v202, v203, v200, s[58:59]
    v_mfma_f32_16x16x32_bf16 v[168:171], a[208:211], a[176:179], v[168:171]
    v_accvgpr_write_b32 a222, v202
    v_mul_u32_u24 v201, 6144, v201
    v_mfma_f32_16x16x32_bf16 v[172:175], a[208:211], a[180:183], v[172:175]
    v_and_b32 v200, 0xfff, v200
    v_add_u32_e64 v200, v200, v201
    v_mfma_f32_16x16x32_bf16 v[176:179], a[208:211], a[184:187], v[176:179]
    v_accvgpr_write_b32 a223, v200
    v_mfma_f32_16x16x32_bf16 v[180:183], a[208:211], a[188:191], v[180:183]
    s_cbranch_vccnz L_sk11
    s_waitcnt lgkmcnt(12)
    v_mfma_f32_16x16x32_bf16 v[184:187], a[212:215], a[176:179], v[184:187]
    ds_read_b64_tr_b16 a[172:173], v25 offset:32768
    v_mfma_f32_16x16x32_bf16 v[188:191], a[212:215], a[180:183], v[188:191]
    ds_read_b64_tr_b16 a[174:175], v25 offset:33792
    v_mfma_f32_16x16x32_bf16 v[192:195], a[212:215], a[184:187], v[192:195]
    v_mfma_f32_16x16x32_bf16 v[196:199], a[212:215], a[188:191], v[196:199]
L_sk11:
    s_waitcnt lgkmcnt(6)
    v_mfma_f32_16x16x32_bf16 v[104:107], a[136:139], a[152:155], v[104:107]
    v_lshrrev_b32 v201, 5, v1
    v_bfe_u32 v200, v1, 2, 2
    v_mfma_f32_16x16x32_bf16 v[108:111], a[140:143], a[152:155], v[108:111]
    ds_read_b128 a[176:179], v19 offset:32768
    v_lshl_add_u32 v202, v201, 3, v200
    v_mfma_f32_16x16x32_bf16 v[112:115], a[144:147], a[152:155], v[112:115]
    ds_read_b128 a[192:195], v21 offset:16384
    v_lshlrev_b32_e64 v202, 8, v202
    v_mfma_f32_16x16x32_bf16 v[116:119], a[148:151], a[152:155], v[116:119]
    ds_read_b128 a[180:183], v19 offset:34816
    v_lshl_add_u32 v202, v200, 6, v202
    v_mfma_f32_16x16x32_bf16 v[120:123], a[136:139], a[156:159], v[120:123]
    ds_read_b128 a[184:187], v19 offset:36864
    v_bfe_u32 v203, v1, 4, 1
    v_mfma_f32_16x16x32_bf16 v[124:127], a[140:143], a[156:159], v[124:127]
    ds_read_b128 a[188:191], v19 offset:38912
    v_lshl_add_u32 v202, v203, 5, v202
    v_mfma_f32_16x16x32_bf16 v[128:131], a[144:147], a[156:159], v[128:131]
    ds_read_b128 a[196:199], v21 offset:20480
    v_and_b32_e64 v203, 3, v1
    v_mfma_f32_16x16x32_bf16 v[132:135], a[148:151], a[156:159], v[132:135]
    v_lshl_add_u32 v202, v203, 3, v202
    s_waitcnt lgkmcnt(6)
    v_mfma_f32_16x16x32_bf16 v[136:139], a[160:163], a[136:139], v[136:139]
    s_lshl_b32 s49, s100, 16
    v_add_u32_e64 v2, s49, v202
    v_mfma_f32_16x16x32_bf16 v[140:143], a[160:163], a[140:143], v[140:143]
    ds_read_b64_tr_b16 a[200:201], v22 offset:40960
    v_xor_b32 v10, 0x10000, v2
    v_mfma_f32_16x16x32_bf16 v[144:147], a[160:163], a[144:147], v[144:147]
    ds_read_b64_tr_b16 a[202:203], v22 offset:41984
    v_xor_b32_e64 v3, 64, v2
    v_mfma_f32_16x16x32_bf16 v[148:151], a[160:163], a[148:151], v[148:151]
    ds_read_b64_tr_b16 a[204:205], v23 offset:40960
    v_xor_b32_e64 v11, 64, v10
    v_mfma_f32_16x16x32_bf16 v[152:155], a[164:167], a[136:139], v[152:155]
    ds_read_b64_tr_b16 a[206:207], v23 offset:41984
    v_xor_b32 v4, 128, v2
    v_mfma_f32_16x16x32_bf16 v[156:159], a[164:167], a[140:143], v[156:159]
    ds_read_b64_tr_b16 a[208:209], v24 offset:40960
    v_xor_b32 v12, 128, v10
    v_mfma_f32_16x16x32_bf16 v[160:163], a[164:167], a[144:147], v[160:163]
    ds_read_b64_tr_b16 a[210:211], v24 offset:41984
    v_xor_b32 v5, 192, v2
    v_mfma_f32_16x16x32_bf16 v[164:167], a[164:167], a[148:151], v[164:167]
    v_xor_b32 v13, 192, v10
    v_lshlrev_b32_e64 v201, 3, v206
    v_mfma_f32_16x16x32_bf16 v[168:171], a[168:171], a[136:139], v[168:171]
    v_add_u32 v204, 0x24000, v201
    v_lshlrev_b32_e64 v200, 1, v201
    v_mfma_f32_16x16x32_bf16 v[172:175], a[168:171], a[140:143], v[172:175]
    s_lshl_b32 s49, s38, 9
    s_lshl_b32 s50, s37, 13
    v_mfma_f32_16x16x32_bf16 v[176:179], a[168:171], a[144:147], v[176:179]
    s_add_u32 s49, s49, s50
    s_add_u32 s49, s49, 4096
    v_mfma_f32_16x16x32_bf16 v[180:183], a[168:171], a[148:151], v[180:183]
    s_cbranch_vccnz L_sk12
    s_waitcnt lgkmcnt(12)
    v_mfma_f32_16x16x32_bf16 v[184:187], a[172:175], a[136:139], v[184:187]
    ds_read_b64_tr_b16 a[212:213], v25 offset:40960
    v_mfma_f32_16x16x32_bf16 v[188:191], a[172:175], a[140:143], v[188:191]
    ds_read_b64_tr_b16 a[214:215], v25 offset:41984
    v_mfma_f32_16x16x32_bf16 v[192:195], a[172:175], a[144:147], v[192:195]
    v_mfma_f32_16x16x32_bf16 v[196:199], a[172:175], a[148:151], v[196:199]
L_sk12:
    s_waitcnt lgkmcnt(6)
    v_mfma_f32_16x16x32_bf16 v[104:107], a[176:179], a[192:195], v[104:107]
    s_waitcnt vmcnt(3)
    s_barrier
    v_mfma_f32_16x16x32_bf16 v[108:111], a[180:183], a[192:195], v[108:111]
    ds_read_b128 a[136:139], v18 offset:49152
    s_cmp_gt_u32 s3, 0
    s_cselect_b32 s51, 0, 6
    v_mfma_f32_16x16x32_bf16 v[112:115], a[184:187], a[192:195], v[112:115]
    ds_read_b128 a[152:155], v20 offset:24576
    s_add_u32 s52, s36, s3
    v_mfma_f32_16x16x32_bf16 v[116:119], a[188:191], a[192:195], v[116:119]
    ds_read_b128 a[140:143], v18 offset:51200
    s_cmp_eq_u32 s36, 3
    s_cselect_b32 s52, s51, s52
    v_mfma_f32_16x16x32_bf16 v[120:123], a[176:179], a[196:199], v[120:123]
    ds_read_b128 a[144:147], v18 offset:53248
    s_lshl_b32 s52, s52, 14
    s_add_u32 m0, s46, 0
    s_add_u32 s52, s52, s53
    buffer_load_dwordx4 v14, s[16:19], s52 offen offset:0 lds
    v_mfma_f32_16x16x32_bf16 v[124:127], a[180:183], a[196:199], v[124:127]
    ds_read_b128 a[148:151], v18 offset:55296
    buffer_load_dwordx4 v15, s[16:19], s52 offen offset:1024 lds
    v_mfma_f32_16x16x32_bf16 v[128:131], a[184:187], a[196:199], v[128:131]
    ds_read_b128 a[156:159], v20 offset:28672
    v_add_u32_e64 v200, s49, v200
    v_mfma_f32_16x16x32_bf16 v[132:135], a[188:191], a[196:199], v[132:135]
    buffer_load_dwordx4 v16, s[16:19], s52 offen offset:2048 lds
    s_waitcnt lgkmcnt(6)
    s_nop 0
    v_mfma_f32_16x16x32_bf16 v[136:139], a[200:203], a[176:179], v[136:139]
    v_mov_b32 v203, 0x80000000
    v_cmp_eq_u32 s[58:59], 7, v42
    v_mfma_f32_16x16x32_bf16 v[140:143], a[200:203], a[180:183], v[140:143]
    ds_read_b64_tr_b16 a[160:161], v22 offset:49152
    buffer_load_dwordx4 v17, s[16:19], s52 offen offset:3072 lds
    v_mfma_f32_16x16x32_bf16 v[144:147], a[200:203], a[184:187], v[144:147]
    ds_read_b64_tr_b16 a[162:163], v22 offset:50176
    s_cmp_gt_u32 s3, 1
    s_cselect_b32 s51, 1, 7
    v_mfma_f32_16x16x32_bf16 v[148:151], a[200:203], a[188:191], v[148:151]
    ds_read_b64_tr_b16 a[164:165], v23 offset:49152
    s_add_u32 s52, s36, s3
    v_mfma_f32_16x16x32_bf16 v[152:155], a[204:207], a[176:179], v[152:155]
    ds_read_b64_tr_b16 a[166:167], v23 offset:50176
    s_add_u32 s52, s52, 3
    v_mfma_f32_16x16x32_bf16 v[156:159], a[204:207], a[180:183], v[156:159]
    ds_read_b64_tr_b16 a[168:169], v24 offset:49152
    s_cmp_eq_u32 s36, 3
    s_cselect_b32 s52, s51, s52
    s_lshl_b32 s52, s52, 14
    s_add_u32 m0, s48, 0
    s_add_u32 s52, s52, s53
    buffer_load_dwordx4 v14, s[16:19], s52 offen offset:0 lds
    v_mfma_f32_16x16x32_bf16 v[160:163], a[204:207], a[184:187], v[160:163]
    ds_read_b64_tr_b16 a[170:171], v24 offset:50176
    buffer_load_dwordx4 v15, s[16:19], s52 offen offset:1024 lds
    v_mfma_f32_16x16x32_bf16 v[164:167], a[204:207], a[188:191], v[164:167]
    v_add_u32 v202, 1, v42
    v_cmp_ge_u32 s[54:55], s37, v202
    v_mfma_f32_16x16x32_bf16 v[168:171], a[208:211], a[176:179], v[168:171]
    buffer_load_dwordx4 v16, s[16:19], s52 offen offset:2048 lds
    v_cndmask_b32 v205, v203, v200, s[58:59]
    v_mfma_f32_16x16x32_bf16 v[172:175], a[208:211], a[180:183], v[172:175]
    v_lshlrev_b32 v201, 13, v202
    v_sub_u32 v201, v200, v201
    v_mfma_f32_16x16x32_bf16 v[176:179], a[208:211], a[184:187], v[176:179]
    v_add_u32_e64 v202, 8, v202
    v_cmp_ge_u32 s[56:57], s37, v202
    v_mfma_f32_16x16x32_bf16 v[180:183], a[208:211], a[188:191], v[180:183]
    s_cbranch_vccnz L_sk13
    s_waitcnt lgkmcnt(12)
    v_mfma_f32_16x16x32_bf16 v[184:187], a[212:215], a[176:179], v[184:187]
    ds_read_b64_tr_b16 a[172:173], v25 offset:49152
    v_mfma_f32_16x16x32_bf16 v[188:191], a[212:215], a[180:183], v[188:191]
    ds_read_b64_tr_b16 a[174:175], v25 offset:50176
    v_mfma_f32_16x16x32_bf16 v[192:195], a[212:215], a[184:187], v[192:195]
    v_mfma_f32_16x16x32_bf16 v[196:199], a[212:215], a[188:191], v[196:199]
L_sk13:
    s_waitcnt lgkmcnt(6)
    v_mfma_f32_16x16x32_bf16 v[104:107], a[136:139], a[152:155], v[104:107]
    ds_read_b128 a[176:179], v19 offset:49152
    buffer_load_dwordx4 v17, s[16:19], s52 offen offset:3072 lds
    v_mfma_f32_16x16x32_bf16 v[108:111], a[140:143], a[152:155], v[108:111]
    ds_read_b128 a[192:195], v21 offset:24576
    s_add_u32 s52, s36, 8
    v_mfma_f32_16x16x32_bf16 v[112:115], a[144:147], a[152:155], v[112:115]
    ds_read_b128 a[180:183], v19 offset:51200
    s_sub_u32 s51, s52, 6
    v_mfma_f32_16x16x32_bf16 v[116:119], a[148:151], a[152:155], v[116:119]
    ds_read_b128 a[184:187], v19 offset:53248
    s_cmp_lt_u32 s51, s3
    s_cselect_b32 s52, s51, s52
    s_lshl_b32 s52, s52, 14
    s_add_u32 m0, s46, 16384
    s_add_u32 s52, s52, s53
    s_nop 0
    buffer_load_dwordx4 v14, s[16:19], s52 offen offset:0 lds
    v_mfma_f32_16x16x32_bf16 v[120:123], a[136:139], a[156:159], v[120:123]
    ds_read_b128 a[188:191], v19 offset:55296
    buffer_load_dwordx4 v15, s[16:19], s52 offen offset:1024 lds
    v_mfma_f32_16x16x32_bf16 v[124:127], a[140:143], a[156:159], v[124:127]
    ds_read_b128 a[196:199], v21 offset:28672
    v_cndmask_b32 v206, v203, v201, s[54:55]
    v_mfma_f32_16x16x32_bf16 v[128:131], a[144:147], a[156:159], v[128:131]
    ds_read_b64_tr_b16 a[200:201], v22 offset:57344
    buffer_load_dwordx4 v16, s[16:19], s52 offen offset:2048 lds
    v_mfma_f32_16x16x32_bf16 v[132:135], a[148:151], a[156:159], v[132:135]
    ds_read_b64_tr_b16 a[202:203], v22 offset:58368
    v_subrev_u32 v201, 0x10000, v201
    s_cbranch_vccnz L_sk14
    s_waitcnt lgkmcnt(8)
    v_mfma_f32_16x16x32_bf16 v[184:187], a[172:175], a[136:139], v[184:187]
    v_mfma_f32_16x16x32_bf16 v[188:191], a[172:175], a[140:143], v[188:191]
    v_mfma_f32_16x16x32_bf16 v[192:195], a[172:175], a[144:147], v[192:195]
    v_mfma_f32_16x16x32_bf16 v[196:199], a[172:175], a[148:151], v[196:199]
L_sk14:
    s_waitcnt lgkmcnt(8)
    v_mfma_f32_16x16x32_bf16 v[136:139], a[160:163], a[136:139], v[136:139]
    ds_read_b64_tr_b16 a[204:205], v23 offset:57344
    buffer_load_dwordx4 v17, s[16:19], s52 offen offset:3072 lds
    v_mfma_f32_16x16x32_bf16 v[140:143], a[160:163], a[140:143], v[140:143]
    ds_read_b64_tr_b16 a[206:207], v23 offset:58368
    v_mov_b32 v46, 0
    v_mfma_f32_16x16x32_bf16 v[144:147], a[160:163], a[144:147], v[144:147]
    ds_read_b64_tr_b16 a[208:209], v24 offset:57344
    v_mov_b32_e64 v47, 0
    v_mfma_f32_16x16x32_bf16 v[148:151], a[160:163], a[148:151], v[148:151]
    ds_read_b64_tr_b16 a[210:211], v24 offset:58368
    v_cndmask_b32 v207, v203, v201, s[56:57]
    s_cbranch_vccnz L_sk15a
    ds_read_b64_tr_b16 a[212:213], v25 offset:57344
    ds_read_b64_tr_b16 a[214:215], v25 offset:58368
L_sk15a:
    s_add_u32 s49, s83, s62
    s_mul_i32 s50, s100, 3072
    s_add_u32 s64, s49, s50
    s_sub_u32 s65, s49, s50
    s_add_u32 s65, s65, 3072
    s_lshl_b32 s50, s100, 10
    s_add_u32 s49, s49, 6144
    s_add_u32 s66, s49, s50
    s_sub_u32 s67, s49, s50
    s_add_u32 s67, s67, 1024
    s_mov_b32 s60, 0
    s_waitcnt lgkmcnt(6)
    v_mfma_f32_16x16x32_bf16 v[104:107], a[176:179], a[192:195], v[104:107]
    s_barrier
    s_waitcnt vmcnt(12)
L_g_chk:
    v_cmp_ne_u32 s[58:59], s41, v87
    s_add_u32 s60, s60, 1
    s_cmp_eq_u64 s[58:59], 0
    s_cbranch_scc1 L_g_ok
    s_cmp_ge_u32 s60, 0x8000
    s_cbranch_scc1 L_g_ok
    buffer_load_dwordx2 v[86:87], v81, s[28:31], 0 offen sc1
    s_waitcnt vmcnt(0)
    s_branch L_g_chk
L_g_ok:
    v_mfma_f32_16x16x32_bf16 v[108:111], a[180:183], a[192:195], v[108:111]
    s_add_u32 s52, s36, 12
    s_sub_u32 s51, s52, 6
    v_mfma_f32_16x16x32_bf16 v[112:115], a[184:187], a[192:195], v[112:115]
    s_cmp_lt_u32 s51, s3
    s_cselect_b32 s52, s51, s52
    v_mfma_f32_16x16x32_bf16 v[116:119], a[188:191], a[192:195], v[116:119]
    s_lshl_b32 s52, s52, 14
    s_add_u32 m0, s48, 16384
    v_mfma_f32_16x16x32_bf16 v[120:123], a[176:179], a[196:199], v[120:123]
    s_add_u32 s52, s52, s53
    s_nop 0
    buffer_load_dwordx4 v14, s[16:19], s52 offen offset:0 lds
    v_mfma_f32_16x16x32_bf16 v[124:127], a[180:183], a[196:199], v[124:127]
    ds_write_b32 v97, v86 offset:256
    ds_read_b128 v[236:239], v98 offset:256
    v_mfma_f32_16x16x32_bf16 v[128:131], a[184:187], a[196:199], v[128:131]
    buffer_load_dwordx4 v15, s[16:19], s52 offen offset:1024 lds
    ds_write_b32 v96, v86
    v_mfma_f32_16x16x32_bf16 v[132:135], a[188:191], a[196:199], v[132:135]
    ds_read_b128 v[208:211], v99 offset:0
    ds_read_b128 v[212:215], v99 offset:16
    v_mfma_f32_16x16x32_bf16 v[152:155], a[164:167], a[136:139], v[152:155]
    ds_read_b128 v[216:219], v99 offset:32
    ds_read_b128 v[220:223], v99 offset:48
    v_mfma_f32_16x16x32_bf16 v[156:159], a[164:167], a[140:143], v[156:159]
    buffer_load_dwordx4 v16, s[16:19], s52 offen offset:2048 lds
    v_mov_b32 v226, s41
    v_mfma_f32_16x16x32_bf16 v[160:163], a[164:167], a[144:147], v[160:163]
    v_mov_b32 v227, s41
    s_waitcnt lgkmcnt(5)
    v_mfma_f32_16x16x32_bf16 v[164:167], a[164:167], a[148:151], v[164:167]
    v_sub_f32 v236, 1.0, v236
    v_sub_f32 v237, 1.0, v237
    v_sub_f32 v238, 1.0, v238
    v_sub_f32 v239, 1.0, v239
    v_cvt_pk_bf16_f32 v236, v236, v237
    v_and_b32 v237, s42, v236
    v_lshlrev_b32 v236, 16, v236
    v_cvt_pk_bf16_f32 v238, v238, v239
    v_and_b32 v239, s42, v238
    v_lshlrev_b32_e64 v238, 16, v238
    s_cbranch_vccnz L_sk15
    s_waitcnt lgkmcnt(0)
    v_mfma_f32_16x16x32_bf16 v[184:187], a[212:215], a[176:179], v[184:187]
    v_mfma_f32_16x16x32_bf16 v[188:191], a[212:215], a[180:183], v[188:191]
    v_mfma_f32_16x16x32_bf16 v[192:195], a[212:215], a[184:187], v[192:195]
    v_mfma_f32_16x16x32_bf16 v[196:199], a[212:215], a[188:191], v[196:199]
L_sk15:
    v_mfma_f32_16x16x32_bf16 v[168:171], a[168:171], a[136:139], v[168:171]
    buffer_load_dwordx4 v17, s[16:19], s52 offen offset:3072 lds
    s_mov_b32 m0, s47
    v_mfma_f32_16x16x32_bf16 v[172:175], a[168:171], a[140:143], v[172:175]
    s_nop 0
    v_fma_f32 v200, v30, v104, v105
    v_mfma_f32_16x16x32_bf16 v[176:179], a[168:171], a[144:147], v[176:179]
    v_fma_f32 v201, v30, v120, v121
    v_fma_f32 v200, -v31, v120, v200
    v_mfma_f32_16x16x32_bf16 v[180:183], a[168:171], a[148:151], v[180:183]
    v_fma_f32 v201, v31, v104, v201
    v_fma_f32 v26, v30, v200, v106
    v_mfma_f32_16x16x32_bf16 v[136:139], a[200:203], a[176:179], v[136:139]
    buffer_load_dwordx4 v82, s[4:7], s69 offen offset:0 lds
    v_fma_f32 v27, v30, v201, v122
    v_mfma_f32_16x16x32_bf16 v[140:143], a[200:203], a[180:183], v[140:143]
    v_fma_f32 v26, -v31, v201, v26
    v_fma_f32 v27, v31, v200, v27
    v_mfma_f32_16x16x32_bf16 v[144:147], a[200:203], a[184:187], v[144:147]
    v_fma_f32 v200, v30, v26, v107
    v_fma_f32 v201, v30, v27, v123
    v_mfma_f32_16x16x32_bf16 v[148:151], a[200:203], a[188:191], v[148:151]
    buffer_load_dwordx4 v83, s[4:7], s69 offen offset:1024 lds
    v_fma_f32 v200, -v31, v27, v200
    v_mfma_f32_16x16x32_bf16 v[152:155], a[204:207], a[176:179], v[152:155]
    v_fma_f32 v201, v31, v26, v201
    v_fma_f32 v26, v30, v200, v108
    v_mfma_f32_16x16x32_bf16 v[156:159], a[204:207], a[180:183], v[156:159]
    v_fma_f32 v27, v30, v201, v124
    v_fma_f32 v26, -v31, v201, v26
    v_mfma_f32_16x16x32_bf16 v[160:163], a[204:207], a[184:187], v[160:163]
    v_fma_f32 v27, v31, v200, v27
    v_fma_f32 v200, v30, v26, v109
    v_mfma_f32_16x16x32_bf16 v[164:167], a[204:207], a[188:191], v[164:167]
    v_fma_f32 v201, v30, v27, v125
    v_fma_f32 v200, -v31, v27, v200
    v_mfma_f32_16x16x32_bf16 v[168:171], a[208:211], a[176:179], v[168:171]
    v_fma_f32 v201, v31, v26, v201
    v_fma_f32 v26, v30, v200, v110
    v_mfma_f32_16x16x32_bf16 v[172:175], a[208:211], a[180:183], v[172:175]
    v_fma_f32 v27, v30, v201, v126
    v_fma_f32 v26, -v31, v201, v26
    v_mfma_f32_16x16x32_bf16 v[176:179], a[208:211], a[184:187], v[176:179]
    v_fma_f32 v27, v31, v200, v27
    v_fma_f32 v200, v30, v26, v111
    v_mfma_f32_16x16x32_bf16 v[180:183], a[208:211], a[188:191], v[180:183]
    v_fma_f32 v201, v30, v27, v127
    v_fma_f32 v200, -v31, v27, v200
    v_fma_f32 v201, v31, v26, v201
    v_fma_f32 v26, v30, v200, v112
    v_fma_f32 v27, v30, v201, v128
    v_fma_f32 v26, -v31, v201, v26
    v_fma_f32 v27, v31, v200, v27
    v_fma_f32 v200, v30, v26, v113
    v_fma_f32 v201, v30, v27, v129
    v_fma_f32 v200, -v31, v27, v200
    v_fma_f32 v201, v31, v26, v201
    v_fma_f32 v26, v30, v200, v114
    v_fma_f32 v27, v30, v201, v130
    v_fma_f32 v26, -v31, v201, v26
    v_fma_f32 v27, v31, v200, v27
    v_fma_f32 v200, v30, v26, v115
    v_fma_f32 v201, v30, v27, v131
    v_fma_f32 v200, -v31, v27, v200
    v_fma_f32 v201, v31, v26, v201
    v_fma_f32 v26, v30, v200, v116
    v_fma_f32 v27, v30, v201, v132
    v_fma_f32 v26, -v31, v201, v26
    v_fma_f32 v27, v31, v200, v27
    v_fma_f32 v200, v30, v26, v117
    v_fma_f32 v201, v30, v27, v133
    v_fma_f32 v200, -v31, v27, v200
    v_fma_f32 v201, v31, v26, v201
    v_fma_f32 v26, v30, v200, v118
    v_fma_f32 v27, v30, v201, v134
    v_fma_f32 v26, -v31, v201, v26
    v_fma_f32 v27, v31, v200, v27
    v_fma_f32 v200, v30, v26, v119
    v_fma_f32 v201, v30, v27, v135
    v_fma_f32 v200, -v31, v27, v200
    v_fma_f32 v201, v31, v26, v201
    ds_write_b64 v0, v[200:201]
    s_waitcnt lgkmcnt(0)
    s_barrier
    ds_read_b64 v[240:241], v204 offset:0
    ds_read_b64 v[242:243], v204 offset:256
    ds_read_b64 v[244:245], v204 offset:512
    ds_read_b64 v[246:247], v204 offset:768
    ds_read_b64 v[248:249], v204 offset:1024
    ds_read_b64 v[250:251], v204 offset:1280
    ds_read_b64 v[252:253], v204 offset:1536
    s_waitcnt lgkmcnt(6)
    v_cmpx_lt_u32 vcc, 0, v42
    v_mov_b32 v46, v240
    v_mov_b32 v47, v241
    s_waitcnt lgkmcnt(5)
    v_cmpx_lt_u32 vcc, 1, v42
    v_fma_f32 v242, v32, v46, v242
    v_fma_f32 v243, v32, v47, v243
    v_fma_f32 v242, -v33, v47, v242
    v_fma_f32 v47, v33, v46, v243
    v_mov_b32_e64 v46, v242
    s_waitcnt lgkmcnt(4)
    v_cmpx_lt_u32 vcc, 2, v42
    v_fma_f32 v244, v32, v46, v244
    v_fma_f32 v245, v32, v47, v245
    v_fma_f32 v244, -v33, v47, v244
    v_fma_f32 v47, v33, v46, v245
    v_mov_b32_e64 v46, v244
    s_waitcnt lgkmcnt(3)
    v_cmpx_lt_u32 vcc, 3, v42
    v_fma_f32 v246, v32, v46, v246
    v_fma_f32 v247, v32, v47, v247
    v_fma_f32 v246, -v33, v47, v246
    v_fma_f32 v47, v33, v46, v247
    v_mov_b32_e64 v46, v246
    s_waitcnt lgkmcnt(2)
    v_cmpx_lt_u32 vcc, 4, v42
    v_fma_f32 v248, v32, v46, v248
    v_fma_f32 v249, v32, v47, v249
    v_fma_f32 v248, -v33, v47, v248
    v_fma_f32 v47, v33, v46, v249
    v_mov_b32_e64 v46, v248
    s_waitcnt lgkmcnt(1)
    v_cmpx_lt_u32 vcc, 5, v42
    v_fma_f32 v250, v32, v46, v250
    v_fma_f32 v251, v32, v47, v251
    v_fma_f32 v250, -v33, v47, v250
    v_fma_f32 v47, v33, v46, v251
    v_mov_b32_e64 v46, v250
    s_waitcnt lgkmcnt(0)
    v_cmpx_lt_u32 vcc, 6, v42
    v_fma_f32 v252, v32, v46, v252
    v_fma_f32 v253, v32, v47, v253
    v_fma_f32 v252, -v33, v47, v252
    v_fma_f32 v47, v33, v46, v253
    v_mov_b32 v46, v252
    s_mov_b64 exec, -1
    v_fma_f32 v224, v32, v46, v200
    s_branch L_pg3
.p2align 12
L_pad3:
    s_branch L_touch_ret
    s_nop 0
L_pg3:
    v_fma_f32 v225, v32, v47, v201
    v_fma_f32 v224, -v33, v47, v224
    v_fma_f32 v225, v33, v46, v225
    buffer_store_dwordx4 v[224:227], v205, s[28:31], 0 offen sc1
    s_cmp_lg_u32 s100, 0
    s_cselect_b64 vcc, -1, 0
    v_pk_mul_f32 v[136:137], v[136:137], v[236:237] op_sel:[0,0] op_sel_hi:[1,0]
    v_pk_mul_f32 v[138:139], v[138:139], v[236:237] op_sel:[0,0] op_sel_hi:[1,0]
    v_pk_mul_f32 v[140:141], v[140:141], v[236:237] op_sel:[0,1] op_sel_hi:[1,1]
    v_pk_mul_f32 v[142:143], v[142:143], v[236:237] op_sel:[0,1] op_sel_hi:[1,1]
    v_pk_mul_f32 v[144:145], v[144:145], v[238:239] op_sel:[0,0] op_sel_hi:[1,0]
    v_pk_mul_f32 v[146:147], v[146:147], v[238:239] op_sel:[0,0] op_sel_hi:[1,0]
    v_pk_mul_f32 v[148:149], v[148:149], v[238:239] op_sel:[0,1] op_sel_hi:[1,1]
    v_pk_mul_f32 v[150:151], v[150:151], v[238:239] op_sel:[0,1] op_sel_hi:[1,1]
    s_cbranch_vccnz L_fo0
    s_nop 0
    v_cvt_pk_bf16_f32 v48, v144, v145
    v_cvt_pk_bf16_f32 v49, v146, v147
    v_cvt_pk_bf16_f32 v50, v148, v149
    v_cvt_pk_bf16_f32 v51, v150, v151
    v_cvt_pk_bf16_f32 v136, v136, v137
    v_cvt_pk_bf16_f32 v137, v138, v139
    v_cvt_pk_bf16_f32 v138, v140, v141
    v_cvt_pk_bf16_f32 v139, v142, v143
    s_branch L_fj0
L_fo0:
    s_nop 0
    v_cvt_pk_bf16_f32 v48, v136, v137
    v_cvt_pk_bf16_f32 v49, v138, v139
    v_cvt_pk_bf16_f32 v50, v140, v141
    v_cvt_pk_bf16_f32 v51, v142, v143
    v_cvt_pk_bf16_f32 v136, v144, v145
    v_cvt_pk_bf16_f32 v137, v146, v147
    v_cvt_pk_bf16_f32 v138, v148, v149
    v_cvt_pk_bf16_f32 v139, v150, v151
L_fj0:
    s_nop 1
    v_permlane16_swap_b32 v48, v50
    v_permlane16_swap_b32 v49, v51
    v_permlane16_swap_b32 v136, v138
    v_permlane16_swap_b32 v137, v139
    s_nop 0
    v_pk_max_i16 v136, v136, 0
    v_pk_max_i16 v137, v137, 0
    v_pk_max_i16 v138, v138, 0
    v_pk_max_i16 v139, v139, 0
    buffer_store_dwordx4 v[136:139], v43, s[28:31], s64 offen offset:0 sc1
    v_pk_max_i16 v48, v48, 0
    v_pk_max_i16 v49, v49, 0
    v_pk_max_i16 v50, v50, 0
    v_pk_max_i16 v51, v51, 0
    ds_write_b128 v101, v[48:51] offset:0
    v_pk_mul_f32 v[152:153], v[152:153], v[236:237] op_sel:[0,0] op_sel_hi:[1,0]
    v_pk_mul_f32 v[154:155], v[154:155], v[236:237] op_sel:[0,0] op_sel_hi:[1,0]
    v_pk_mul_f32 v[156:157], v[156:157], v[236:237] op_sel:[0,1] op_sel_hi:[1,1]
    v_pk_mul_f32 v[158:159], v[158:159], v[236:237] op_sel:[0,1] op_sel_hi:[1,1]
    v_pk_mul_f32 v[160:161], v[160:161], v[238:239] op_sel:[0,0] op_sel_hi:[1,0]
    v_pk_mul_f32 v[162:163], v[162:163], v[238:239] op_sel:[0,0] op_sel_hi:[1,0]
    v_pk_mul_f32 v[164:165], v[164:165], v[238:239] op_sel:[0,1] op_sel_hi:[1,1]
    v_pk_mul_f32 v[166:167], v[166:167], v[238:239] op_sel:[0,1] op_sel_hi:[1,1]
    s_cbranch_vccnz L_fo1
    s_nop 0
    v_cvt_pk_bf16_f32 v52, v160, v161
    v_cvt_pk_bf16_f32 v53, v162, v163
    v_cvt_pk_bf16_f32 v54, v164, v165
    v_cvt_pk_bf16_f32 v55, v166, v167
    v_cvt_pk_bf16_f32 v140, v152, v153
    v_cvt_pk_bf16_f32 v141, v154, v155
    v_cvt_pk_bf16_f32 v142, v156, v157
    v_cvt_pk_bf16_f32 v143, v158, v159
    s_branch L_fj1
L_fo1:
    s_nop 0
    v_cvt_pk_bf16_f32 v52, v152, v153
    v_cvt_pk_bf16_f32 v53, v154, v155
    v_cvt_pk_bf16_f32 v54, v156, v157
    v_cvt_pk_bf16_f32 v55, v158, v159
    v_cvt_pk_bf16_f32 v140, v160, v161
    v_cvt_pk_bf16_f32 v141, v162, v163
    v_cvt_pk_bf16_f32 v142, v164, v165
    v_cvt_pk_bf16_f32 v143, v166, v167
L_fj1:
    s_nop 1
    v_permlane16_swap_b32 v52, v54
    v_permlane16_swap_b32 v53, v55
    v_permlane16_swap_b32 v140, v142
    v_permlane16_swap_b32 v141, v143
    s_nop 0
    v_pk_max_i16 v140, v140, 0
    v_pk_max_i16 v141, v141, 0
    v_pk_max_i16 v142, v142, 0
    v_pk_max_i16 v143, v143, 0
    buffer_store_dwordx4 v[140:143], v43, s[28:31], s64 offen offset:1024 sc1
    v_pk_max_i16 v52, v52, 0
    v_pk_max_i16 v53, v53, 0
    v_pk_max_i16 v54, v54, 0
    v_pk_max_i16 v55, v55, 0
    ds_write_b128 v101, v[52:55] offset:1024
    v_pk_mul_f32 v[168:169], v[168:169], v[236:237] op_sel:[0,0] op_sel_hi:[1,0]
    v_pk_mul_f32 v[170:171], v[170:171], v[236:237] op_sel:[0,0] op_sel_hi:[1,0]
    v_pk_mul_f32 v[172:173], v[172:173], v[236:237] op_sel:[0,1] op_sel_hi:[1,1]
    v_pk_mul_f32 v[174:175], v[174:175], v[236:237] op_sel:[0,1] op_sel_hi:[1,1]
    v_pk_mul_f32 v[176:177], v[176:177], v[238:239] op_sel:[0,0] op_sel_hi:[1,0]
    v_pk_mul_f32 v[178:179], v[178:179], v[238:239] op_sel:[0,0] op_sel_hi:[1,0]
    v_pk_mul_f32 v[180:181], v[180:181], v[238:239] op_sel:[0,1] op_sel_hi:[1,1]
    v_pk_mul_f32 v[182:183], v[182:183], v[238:239] op_sel:[0,1] op_sel_hi:[1,1]
    s_cbranch_vccnz L_fo2
    s_nop 0
    v_cvt_pk_bf16_f32 v56, v176, v177
    v_cvt_pk_bf16_f32 v57, v178, v179
    v_cvt_pk_bf16_f32 v58, v180, v181
    v_cvt_pk_bf16_f32 v59, v182, v183
    v_cvt_pk_bf16_f32 v144, v168, v169
    v_cvt_pk_bf16_f32 v145, v170, v171
    v_cvt_pk_bf16_f32 v146, v172, v173
    v_cvt_pk_bf16_f32 v147, v174, v175
    s_branch L_fj2
L_fo2:
    s_nop 0
    v_cvt_pk_bf16_f32 v56, v168, v169
    v_cvt_pk_bf16_f32 v57, v170, v171
    v_cvt_pk_bf16_f32 v58, v172, v173
    v_cvt_pk_bf16_f32 v59, v174, v175
    v_cvt_pk_bf16_f32 v144, v176, v177
    v_cvt_pk_bf16_f32 v145, v178, v179
    v_cvt_pk_bf16_f32 v146, v180, v181
    v_cvt_pk_bf16_f32 v147, v182, v183
L_fj2:
    s_nop 1
    v_permlane16_swap_b32 v56, v58
    v_permlane16_swap_b32 v57, v59
    v_permlane16_swap_b32 v144, v146
    v_permlane16_swap_b32 v145, v147
    s_nop 0
    v_pk_max_i16 v144, v144, 0
    v_pk_max_i16 v145, v145, 0
    v_pk_max_i16 v146, v146, 0
    v_pk_max_i16 v147, v147, 0
    buffer_store_dwordx4 v[144:147], v43, s[28:31], s64 offen offset:2048 sc1
    v_pk_max_i16 v56, v56, 0
    v_pk_max_i16 v57, v57, 0
    v_pk_max_i16 v58, v58, 0
    v_pk_max_i16 v59, v59, 0
    ds_write_b128 v101, v[56:59] offset:2048
    v_pk_mul_f32 v[184:185], v[184:185], v[236:237] op_sel:[0,0] op_sel_hi:[1,0]
    v_pk_mul_f32 v[186:187], v[186:187], v[236:237] op_sel:[0,0] op_sel_hi:[1,0]
    v_pk_mul_f32 v[188:189], v[188:189], v[236:237] op_sel:[0,1] op_sel_hi:[1,1]
    v_pk_mul_f32 v[190:191], v[190:191], v[236:237] op_sel:[0,1] op_sel_hi:[1,1]
    v_pk_mul_f32 v[192:193], v[192:193], v[238:239] op_sel:[0,0] op_sel_hi:[1,0]
    v_pk_mul_f32 v[194:195], v[194:195], v[238:239] op_sel:[0,0] op_sel_hi:[1,0]
    v_pk_mul_f32 v[196:197], v[196:197], v[238:239] op_sel:[0,1] op_sel_hi:[1,1]
    v_pk_mul_f32 v[198:199], v[198:199], v[238:239] op_sel:[0,1] op_sel_hi:[1,1]
    s_cbranch_vccnz L_fo3
    s_nop 0
    v_cvt_pk_bf16_f32 v60, v192, v193
    v_cvt_pk_bf16_f32 v61, v194, v195
    v_cvt_pk_bf16_f32 v62, v196, v197
    v_cvt_pk_bf16_f32 v63, v198, v199
    v_cvt_pk_bf16_f32 v148, v184, v185
    v_cvt_pk_bf16_f32 v149, v186, v187
    v_cvt_pk_bf16_f32 v150, v188, v189
    v_cvt_pk_bf16_f32 v151, v190, v191
    s_branch L_fj3
L_fo3:
    s_nop 0
    v_cvt_pk_bf16_f32 v60, v184, v185
    v_cvt_pk_bf16_f32 v61, v186, v187
    v_cvt_pk_bf16_f32 v62, v188, v189
    v_cvt_pk_bf16_f32 v63, v190, v191
    v_cvt_pk_bf16_f32 v148, v192, v193
    v_cvt_pk_bf16_f32 v149, v194, v195
    v_cvt_pk_bf16_f32 v150, v196, v197
    v_cvt_pk_bf16_f32 v151, v198, v199
L_fj3:
    s_nop 1
    v_permlane16_swap_b32 v60, v62
    v_permlane16_swap_b32 v61, v63
    v_permlane16_swap_b32 v148, v150
    v_permlane16_swap_b32 v149, v151
    s_nop 0
    v_pk_max_i16 v148, v148, 0
    v_pk_max_i16 v149, v149, 0
    v_pk_max_i16 v150, v150, 0
    v_pk_max_i16 v151, v151, 0
    buffer_store_dwordx4 v[148:151], v44, s[28:31], s66 offen offset:0 sc1
    v_pk_max_i16 v60, v60, 0
    v_pk_max_i16 v61, v61, 0
    v_pk_max_i16 v62, v62, 0
    v_pk_max_i16 v63, v63, 0
    ds_write_b128 v101, v[60:63] offset:3072
    buffer_load_dwordx4 v[228:231], v206, s[28:31], 0 offen sc1
    buffer_load_dwordx4 v[232:235], v207, s[28:31], 0 offen sc1
    s_waitcnt vmcnt(9)
    s_waitcnt lgkmcnt(0)
    s_barrier
    ds_read_b128 v[152:155], v102 offset:0
    ds_read_b128 v[156:159], v102 offset:1024
    ds_read_b128 v[160:163], v102 offset:2048
    ds_read_b128 v[164:167], v102 offset:3072
    s_waitcnt lgkmcnt(3)
    buffer_store_dwordx4 v[152:155], v43, s[28:31], s65 offen offset:0 sc1
    s_waitcnt lgkmcnt(2)
    buffer_store_dwordx4 v[156:159], v43, s[28:31], s65 offen offset:1024 sc1
    s_waitcnt lgkmcnt(1)
    buffer_store_dwordx4 v[160:163], v43, s[28:31], s65 offen offset:2048 sc1
    s_waitcnt lgkmcnt(0)
    buffer_store_dwordx4 v[164:167], v44, s[28:31], s67 offen offset:0 sc1
    s_and_b32 s49, s40, 1
    s_lshl_b32 s49, s49, 6
    v_xor_b32 v18, s49, v103
    v_add_u32 v22, 0x20000, v18
    v_xor_b32 v19, 32, v18
    v_xor_b32 v23, 32, v22
    v_xor_b32 v20, 64, v18
    v_xor_b32 v24, 64, v22
    s_add_u32 s52, s36, 16
    s_sub_u32 s51, s52, 6
    s_cmp_lt_u32 s51, s3
    s_cselect_b32 s52, s51, s52
    s_lshl_b32 s52, s52, 14
    s_add_u32 m0, s46, 32768
    s_add_u32 s52, s52, s53
    buffer_load_dwordx4 v14, s[16:19], s52 offen offset:0 lds
    v_xor_b32 v21, 96, v18
    v_xor_b32 v25, 96, v22
    v_mul_f32 v200, v104, v41
    v_mul_f32 v104, v104, v40
    v_fma_f32 v104, -v120, v41, v104
    v_fma_f32 v120, v120, v40, v200
    v_mul_f32 v201, v105, v41
    v_mul_f32 v105, v105, v40
    v_fma_f32 v105, -v121, v41, v105
    v_fma_f32 v121, v121, v40, v201
    v_mul_f32 v200, v106, v41
    v_mul_f32 v106, v106, v40
    v_fma_f32 v106, -v122, v41, v106
    v_fma_f32 v122, v122, v40, v200
    v_mul_f32 v201, v107, v41
    v_mul_f32 v107, v107, v40
    buffer_load_dwordx4 v15, s[16:19], s52 offen offset:1024 lds
    v_fma_f32 v107, -v123, v41, v107
    v_fma_f32 v123, v123, v40, v201
    v_mul_f32 v200, v108, v41
    v_mul_f32 v108, v108, v40
    v_fma_f32 v108, -v124, v41, v108
    v_fma_f32 v124, v124, v40, v200
    v_mul_f32 v201, v109, v41
    v_mul_f32 v109, v109, v40
    v_fma_f32 v109, -v125, v41, v109
    v_fma_f32 v125, v125, v40, v201
    v_mul_f32 v200, v110, v41
    v_mul_f32 v110, v110, v40
    v_fma_f32 v110, -v126, v41, v110
    v_fma_f32 v126, v126, v40, v200
    v_mul_f32 v201, v111, v41
    v_mul_f32 v111, v111, v40
    v_fma_f32 v111, -v127, v41, v111
    v_fma_f32 v127, v127, v40, v201
    v_mul_f32 v200, v112, v41
    v_mul_f32 v112, v112, v40
    v_fma_f32 v112, -v128, v41, v112
    v_fma_f32 v128, v128, v40, v200
    v_mul_f32 v201, v113, v41
    v_mul_f32 v113, v113, v40
    buffer_load_dwordx4 v16, s[16:19], s52 offen offset:2048 lds
    v_fma_f32 v113, -v129, v41, v113
    v_fma_f32 v129, v129, v40, v201
    v_mul_f32 v200, v114, v41
    v_mul_f32 v114, v114, v40
    v_fma_f32 v114, -v130, v41, v114
    v_fma_f32 v130, v130, v40, v200
    v_mul_f32 v201, v115, v41
    v_mul_f32 v115, v115, v40
    v_fma_f32 v115, -v131, v41, v115
    v_fma_f32 v131, v131, v40, v201
    v_mul_f32 v200, v116, v41
    v_mul_f32 v116, v116, v40
    v_fma_f32 v116, -v132, v41, v116
    v_fma_f32 v132, v132, v40, v200
    v_mul_f32 v201, v117, v41
    v_mul_f32 v117, v117, v40
    buffer_load_dwordx4 v17, s[16:19], s52 offen offset:3072 lds
    v_fma_f32 v117, -v133, v41, v117
    v_fma_f32 v133, v133, v40, v201
    v_mul_f32 v200, v118, v41
    v_mul_f32 v118, v118, v40
    v_fma_f32 v118, -v134, v41, v118
    v_fma_f32 v134, v134, v40, v200
    v_mul_f32 v201, v119, v41
    v_mul_f32 v119, v119, v40
    v_fma_f32 v119, -v135, v41, v119
    v_fma_f32 v135, v135, v40, v201
    v_accvgpr_read_b32 v26, a216
    v_accvgpr_read_b32 v101, a217
    v_accvgpr_read_b32 v96, a218
    v_accvgpr_read_b32 v98, a219
    v_accvgpr_read_b32 v99, a220
    v_accvgpr_read_b32 v205, a222
    v_accvgpr_read_b32 v103, a223
    s_add_u32 s65, s83, s62
    v_xor_b32 v27, 16, v26
    v_xor_b32_e64 v102, 64, v101
    v_add_u32 v102, 512, v102
    s_mov_b32 s44, 32768
    s_mov_b32 s60, 0
    v_accvgpr_read_b32 v44, a221
    s_sub_u32 s64, s83, 6144
    s_add_u32 s71, s68, 32768
    s_waitcnt vmcnt(8)
    v_lshlrev_b32 v29, 16, v29
L_lb_chk:
    v_cmp_ne_u32 vcc, s41, v230
    v_cmp_ne_u32 s[58:59], s41, v234
    s_and_b64 vcc, vcc, s[54:55]
    s_and_b64 s[58:59], s[58:59], s[56:57]
    s_or_b64 vcc, vcc, s[58:59]
    s_cbranch_scc0 L_lb_ok
    s_add_u32 s60, s60, 1
    s_cmp_ge_u32 s60, 0x8000
    s_cbranch_scc1 L_lb_ok
    buffer_load_dwordx4 v[228:231], v206, s[28:31], 0 offen sc1
    buffer_load_dwordx4 v[232:235], v207, s[28:31], 0 offen sc1
    s_waitcnt vmcnt(0)
    s_branch L_lb_chk
L_lb_ok:
    v_fma_f32 v228, v38, v232, v228
    v_fma_f32 v229, v38, v233, v229
    v_fma_f32 v228, -v39, v233, v228
    v_fma_f32 v229, v39, v232, v229
    v_mul_f32 v232, v36, v228
    v_mul_f32 v233, v36, v229
    v_fma_f32 v232, -v37, v229, v232
    v_fma_f32 v233, v37, v228, v233
    ds_write_b64 v0, v[232:233] offset:2048
    s_waitcnt lgkmcnt(0)
    s_barrier
    ds_read_b64 v[224:225], v204 offset:2048
    ds_read_b64 v[226:227], v204 offset:2304
    ds_read_b64 v[228:229], v204 offset:2560
    ds_read_b64 v[230:231], v204 offset:2816
    ds_read_b64 v[232:233], v204 offset:3072
    ds_read_b64 v[234:235], v204 offset:3328
    ds_read_b64 v[236:237], v204 offset:3584
    ds_read_b64 v[238:239], v204 offset:3840
    ds_read_b64_tr_b16 v[168:169], v2 offset:0
    ds_read_b64_tr_b16 v[170:171], v2 offset:1024
    ds_read_b64_tr_b16 v[172:173], v3 offset:0
    ds_read_b64_tr_b16 v[174:175], v3 offset:1024
    ds_read_b64_tr_b16 v[176:177], v4 offset:0
    ds_read_b64_tr_b16 v[178:179], v4 offset:1024
    ds_read_b64_tr_b16 v[180:181], v5 offset:0
    s_waitcnt lgkmcnt(13)
    v_pk_add_f32 v[224:225], v[224:225], v[226:227]
    s_waitcnt lgkmcnt(12)
    v_pk_add_f32 v[224:225], v[224:225], v[228:229]
    s_waitcnt lgkmcnt(11)
    v_pk_add_f32 v[224:225], v[224:225], v[230:231]
    s_waitcnt lgkmcnt(10)
    v_pk_add_f32 v[224:225], v[224:225], v[232:233]
    s_waitcnt lgkmcnt(9)
    v_pk_add_f32 v[224:225], v[224:225], v[234:235]
    s_waitcnt lgkmcnt(8)
    v_pk_add_f32 v[224:225], v[224:225], v[236:237]
    s_waitcnt lgkmcnt(7)
    v_pk_add_f32 v[224:225], v[224:225], v[238:239]
    v_fma_f32 v46, v34, v224, v46
    v_fma_f32 v47, v34, v225, v47
    v_fma_f32 v46, -v35, v225, v46
    v_fma_f32 v47, v35, v224, v47
    v_mul_f32 v200, v40, v46
    v_mul_f32_e64 v201, v40, v47
    v_fma_f32 v200, -v41, v47, v200
    v_fma_f32 v201, v41, v46, v201
    s_waitcnt vmcnt(4)
    s_mov_b64 exec, 1
    buffer_store_dword v45, off, s[28:31], s68 sc1
    s_mov_b64 exec, -1
    s_nop 1
    ds_read_b64_tr_b16 v[182:183], v5 offset:1024
    s_waitcnt lgkmcnt(6)
    v_mfma_f32_32x32x16_bf16 v[48:63], v[136:139], v[168:171], 0
    ds_read_b64_tr_b16 v[184:185], v2 offset:4096
    ds_read_b64_tr_b16 v[186:187], v2 offset:5120
    ds_read_b64_tr_b16 v[188:189], v3 offset:4096
    v_fma_f32 v104, v30, v200, v104
    v_fma_f32 v120, v30, v201, v120
    s_waitcnt lgkmcnt(7)
    v_mfma_f32_32x32x16_bf16 v[64:79], v[136:139], v[172:175], 0
    ds_read_b64_tr_b16 v[190:191], v3 offset:5120
    ds_read_b64_tr_b16 v[192:193], v4 offset:4096
    ds_read_b64_tr_b16 v[194:195], v4 offset:5120
    s_add_u32 s52, s36, 20
    s_sub_u32 s51, s52, 6
    s_cmp_lt_u32 s51, s3
    s_cselect_b32 s52, s51, s52
    s_lshl_b32 s52, s52, 14
    s_add_u32 m0, s48, 32768
    s_add_u32 s52, s52, s53
    buffer_load_dwordx4 v14, s[16:19], s52 offen offset:0 lds
    v_fma_f32 v104, -v31, v201, v104
    s_waitcnt lgkmcnt(8)
    v_mfma_f32_32x32x16_bf16 v[80:95], v[136:139], v[176:179], 0
    ds_read_b64_tr_b16 v[196:197], v5 offset:4096
    ds_read_b64_tr_b16 v[198:199], v5 offset:5120
    v_fma_f32 v120, v31, v200, v120
    v_fma_f32 v105, v30, v104, v105
    v_fma_f32 v121, v30, v120, v121
    s_waitcnt lgkmcnt(8)
    v_mfma_f32_32x32x16_bf16 v[240:255], v[136:139], v[180:183], 0
    buffer_load_dwordx4 v15, s[16:19], s52 offen offset:1024 lds
    v_fma_f32 v105, -v31, v120, v105
    v_fma_f32 v121, v31, v104, v121
    v_fma_f32 v106, v30, v105, v106
    v_fma_f32 v122, v30, v121, v122
    s_waitcnt lgkmcnt(6)
    v_mfma_f32_32x32x16_bf16 v[48:63], v[140:143], v[184:187], v[48:63]
    ds_read_b64_tr_b16 v[168:169], v2 offset:8192
    ds_read_b64_tr_b16 v[170:171], v2 offset:9216
    ds_read_b64_tr_b16 v[172:173], v3 offset:8192
    v_fma_f32 v106, -v31, v121, v106
    v_fma_f32 v122, v31, v105, v122
    s_waitcnt lgkmcnt(7)
    v_mfma_f32_32x32x16_bf16 v[64:79], v[140:143], v[188:191], v[64:79]
    ds_read_b64_tr_b16 v[174:175], v3 offset:9216
    ds_read_b64_tr_b16 v[176:177], v4 offset:8192
    ds_read_b64_tr_b16 v[178:179], v4 offset:9216
    v_fma_f32 v107, v30, v106, v107
    v_fma_f32 v123, v30, v122, v123
    s_waitcnt lgkmcnt(8)
    v_mfma_f32_32x32x16_bf16 v[80:95], v[140:143], v[192:195], v[80:95]
    ds_read_b64_tr_b16 v[180:181], v5 offset:8192
    ds_read_b64_tr_b16 v[182:183], v5 offset:9216
    buffer_load_dwordx4 v16, s[16:19], s52 offen offset:2048 lds
    v_fma_f32 v107, -v31, v122, v107
    v_fma_f32 v123, v31, v106, v123
    s_waitcnt lgkmcnt(8)
    v_mfma_f32_32x32x16_bf16 v[240:255], v[140:143], v[196:199], v[240:255]
    v_fma_f32 v108, v30, v107, v108
    v_fma_f32 v124, v30, v123, v124
    v_fma_f32 v108, -v31, v123, v108
    v_fma_f32 v124, v31, v107, v124
    v_fma_f32 v109, v30, v108, v109
    s_waitcnt lgkmcnt(6)
    v_mfma_f32_32x32x16_bf16 v[48:63], v[144:147], v[168:171], v[48:63]
    ds_read_b64_tr_b16 v[184:185], v10 offset:0
    ds_read_b64_tr_b16 v[186:187], v10 offset:1024
    ds_read_b64_tr_b16 v[188:189], v11 offset:0
    buffer_load_dwordx4 v17, s[16:19], s52 offen offset:3072 lds
    v_fma_f32 v125, v30, v124, v125
    s_waitcnt lgkmcnt(7)
    v_mfma_f32_32x32x16_bf16 v[64:79], v[144:147], v[172:175], v[64:79]
    ds_read_b64_tr_b16 v[190:191], v11 offset:1024
    ds_read_b64_tr_b16 v[192:193], v12 offset:0
    ds_read_b64_tr_b16 v[194:195], v12 offset:1024
    v_fma_f32 v109, -v31, v124, v109
    v_fma_f32 v125, v31, v108, v125
    s_waitcnt lgkmcnt(8)
    v_mfma_f32_32x32x16_bf16 v[80:95], v[144:147], v[176:179], v[80:95]
    ds_read_b64_tr_b16 v[196:197], v13 offset:0
    ds_read_b64_tr_b16 v[198:199], v13 offset:1024
    v_fma_f32 v110, v30, v109, v110
    v_fma_f32 v126, v30, v125, v126
    v_fma_f32 v110, -v31, v125, v110
    s_waitcnt lgkmcnt(8)
    v_mfma_f32_32x32x16_bf16 v[240:255], v[144:147], v[180:183], v[240:255]
    v_fma_f32 v126, v31, v109, v126
    v_fma_f32 v111, v30, v110, v111
    v_fma_f32 v127, v30, v126, v127
    v_fma_f32 v111, -v31, v126, v111
    v_fma_f32 v127, v31, v110, v127
    s_waitcnt lgkmcnt(6)
    v_mfma_f32_32x32x16_bf16 v[48:63], v[152:155], v[184:187], v[48:63]
    ds_read_b64_tr_b16 v[168:169], v10 offset:4096
    ds_read_b64_tr_b16 v[170:171], v10 offset:5120
    ds_read_b64_tr_b16 v[172:173], v11 offset:4096
    v_fma_f32 v112, v30, v111, v112
    v_fma_f32 v128, v30, v127, v128
    s_waitcnt lgkmcnt(7)
    v_mfma_f32_32x32x16_bf16 v[64:79], v[152:155], v[188:191], v[64:79]
    ds_read_b64_tr_b16 v[174:175], v11 offset:5120
    ds_read_b64_tr_b16 v[176:177], v12 offset:4096
    ds_read_b64_tr_b16 v[178:179], v12 offset:5120
    v_fma_f32 v112, -v31, v127, v112
    v_fma_f32 v128, v31, v111, v128
    s_waitcnt lgkmcnt(8)
    v_mfma_f32_32x32x16_bf16 v[80:95], v[152:155], v[192:195], v[80:95]
    ds_read_b64_tr_b16 v[180:181], v13 offset:4096
    ds_read_b64_tr_b16 v[182:183], v13 offset:5120
    v_fma_f32 v113, v30, v112, v113
    v_fma_f32 v129, v30, v128, v129
    v_fma_f32 v113, -v31, v128, v113
    s_waitcnt lgkmcnt(8)
    v_mfma_f32_32x32x16_bf16 v[240:255], v[152:155], v[196:199], v[240:255]
    v_fma_f32 v129, v31, v112, v129
    v_fma_f32 v114, v30, v113, v114
    v_fma_f32 v130, v30, v129, v130
    v_fma_f32 v114, -v31, v129, v114
    v_fma_f32 v130, v31, v113, v130
    buffer_load_dword v97, v28, s[28:31], 0 offen sc1
    s_waitcnt lgkmcnt(6)
    v_mfma_f32_32x32x16_bf16 v[48:63], v[156:159], v[168:171], v[48:63]
    ds_read_b64_tr_b16 v[184:185], v10 offset:8192
    ds_read_b64_tr_b16 v[186:187], v10 offset:9216
    ds_read_b64_tr_b16 v[188:189], v11 offset:8192
    s_add_u32 s52, s36, 24
    s_sub_u32 s51, s52, 6
    s_cmp_lt_u32 s51, s3
    s_cselect_b32 s52, s51, s52
    s_lshl_b32 s52, s52, 14
    s_add_u32 m0, s48, 49152
    s_add_u32 s52, s52, s53
    buffer_load_dwordx4 v14, s[16:19], s52 offen offset:0 lds
    v_fma_f32 v115, v30, v114, v115
    s_waitcnt lgkmcnt(7)
    v_mfma_f32_32x32x16_bf16 v[64:79], v[156:159], v[172:175], v[64:79]
    ds_read_b64_tr_b16 v[190:191], v11 offset:9216
    ds_read_b64_tr_b16 v[192:193], v12 offset:8192
    ds_read_b64_tr_b16 v[194:195], v12 offset:9216
    buffer_load_dwordx4 v15, s[16:19], s52 offen offset:1024 lds
    v_fma_f32 v131, v30, v130, v131
    s_waitcnt lgkmcnt(8)
    v_mfma_f32_32x32x16_bf16 v[80:95], v[156:159], v[176:179], v[80:95]
    ds_read_b64_tr_b16 v[196:197], v13 offset:8192
    ds_read_b64_tr_b16 v[198:199], v13 offset:9216
    buffer_load_dwordx4 v16, s[16:19], s52 offen offset:2048 lds
    v_fma_f32 v115, -v31, v130, v115
    v_fma_f32 v131, v31, v114, v131
    s_waitcnt lgkmcnt(8)
    v_mfma_f32_32x32x16_bf16 v[240:255], v[156:159], v[180:183], v[240:255]
    buffer_load_dwordx4 v17, s[16:19], s52 offen offset:3072 lds
    v_fma_f32 v116, v30, v115, v116
    v_fma_f32 v132, v30, v131, v132
    v_fma_f32 v116, -v31, v131, v116
    v_fma_f32 v132, v31, v115, v132
    s_waitcnt lgkmcnt(6)
    v_mfma_f32_32x32x16_bf16 v[48:63], v[160:163], v[184:187], v[48:63]
    s_add_u32 m0, s46, 49152
    s_nop 0
    buffer_load_dwordx4 v6, s[20:23], s61 offen offset:0 lds
    v_fma_f32 v117, v30, v116, v117
    v_fma_f32 v133, v30, v132, v133
    s_waitcnt lgkmcnt(4)
    v_mfma_f32_32x32x16_bf16 v[64:79], v[160:163], v[188:191], v[64:79]
    buffer_load_dwordx4 v7, s[20:23], s61 offen offset:1024 lds
    v_fma_f32 v117, -v31, v132, v117
    v_fma_f32 v133, v31, v116, v133
    v_fma_f32 v118, v30, v117, v118
    v_fma_f32 v134, v30, v133, v134
    s_waitcnt lgkmcnt(2)
    v_mfma_f32_32x32x16_bf16 v[80:95], v[160:163], v[192:195], v[80:95]
    buffer_load_dwordx4 v8, s[20:23], s61 offen offset:2048 lds
    v_fma_f32 v118, -v31, v133, v118
    v_fma_f32 v134, v31, v117, v134
    v_fma_f32 v119, v30, v118, v119
    v_fma_f32 v135, v30, v134, v135
    s_waitcnt lgkmcnt(0)
    v_mfma_f32_32x32x16_bf16 v[240:255], v[160:163], v[196:199], v[240:255]
    buffer_load_dwordx4 v9, s[20:23], s61 offen offset:3072 lds
    v_fma_f32 v119, -v31, v134, v119
    v_fma_f32 v135, v31, v118, v135
    s_lshl_b32 s49, s100, 16
    v_xor_b32 v2, s49, v2
    v_xor_b32 v10, s49, v10
    v_xor_b32 v3, s49, v3
    v_xor_b32 v11, s49, v11
    v_xor_b32 v4, s49, v4
    v_xor_b32 v12, s49, v12
    v_xor_b32 v5, s49, v5
    v_xor_b32_e64 v13, s49, v13
    ds_read_u16 v224, v96 offset:0
    ds_read_u16 v225, v96 offset:64
    ds_read_u16 v226, v96 offset:128
    ds_read_u16 v227, v96 offset:192
    ds_read_u16 v228, v96 offset:256
    ds_read_u16 v229, v96 offset:320
    ds_read_u16 v230, v96 offset:384
    ds_read_u16 v231, v96 offset:448
    ds_read_u16 v232, v96 offset:512
    ds_read_u16 v233, v96 offset:576
    ds_read_u16 v234, v96 offset:640
    ds_read_u16 v235, v96 offset:704
    ds_read_u16 v236, v96 offset:768
    ds_read_u16 v237, v96 offset:832
    s_waitcnt lgkmcnt(10)
    ds_read_u16 v238, v96 offset:896
    ds_read_u16 v239, v96 offset:960
    s_waitcnt vmcnt(8)
    s_mov_b32 s60, 0
L_f0_chk:
    v_cmp_ne_u32 vcc, s41, v97
    s_add_u32 s60, s60, 1
    s_cbranch_vccz L_f0_ok
    s_cmp_ge_u32 s60, 0x8000
    s_cbranch_scc1 L_f0_ok
    buffer_load_dword v97, v28, s[28:31], 0 offen sc1
    s_waitcnt vmcnt(0)
    s_branch L_f0_chk
L_f0_ok:
    v_pk_mul_f32 v[104:105], v[104:105], v[208:209]
    v_pk_mul_f32 v[106:107], v[106:107], v[210:211]
    v_pk_mul_f32 v[108:109], v[108:109], v[212:213]
    v_pk_mul_f32 v[110:111], v[110:111], v[214:215]
    s_cmp_gt_u32 s3, 0
    s_cselect_b32 s43, s64, s83
    s_add_u32 s43, s43, 6144
    buffer_load_dwordx4 a[0:3], v43, s[28:31], s43 offen offset:0 sc1
    v_pk_mul_f32 v[112:113], v[112:113], v[216:217]
    v_pk_mul_f32 v[114:115], v[114:115], v[218:219]
    v_pk_mul_f32 v[116:117], v[116:117], v[220:221]
    v_pk_mul_f32 v[118:119], v[118:119], v[222:223]
    buffer_load_dwordx4 a[4:7], v43, s[28:31], s43 offen offset:1024 sc1
    s_branch L_pg4
.p2align 12
L_pad4:
    s_branch L_touch_ret
    s_nop 0
L_pg4:
    v_cvt_pk_bf16_f32 v104, v104, v105
    v_cvt_pk_bf16_f32 v105, v106, v107
    v_cvt_pk_bf16_f32 v106, v108, v109
    v_cvt_pk_bf16_f32 v107, v110, v111
    s_cmp_gt_u32 s3, 2
    s_cselect_b32 s43, s64, s83
    s_add_u32 s43, s43, 8192
    buffer_load_dwordx4 a[8:11], v43, s[28:31], s43 offen offset:0 sc1
    v_cvt_pk_bf16_f32 v108, v112, v113
    v_cvt_pk_bf16_f32 v109, v114, v115
    v_cvt_pk_bf16_f32 v110, v116, v117
    v_cvt_pk_bf16_f32 v111, v118, v119
    buffer_load_dwordx4 a[12:15], v43, s[28:31], s43 offen offset:1024 sc1
    s_waitcnt lgkmcnt(0)
    ds_write_b128 v26, v[104:107] offset:16384
    ds_write_b128 v27, v[108:111] offset:16384
    v_pk_mul_f32 v[120:121], v[120:121], v[208:209]
    v_pk_mul_f32 v[122:123], v[122:123], v[210:211]
    v_pk_mul_f32 v[124:125], v[124:125], v[212:213]
    v_pk_mul_f32 v[126:127], v[126:127], v[214:215]
    s_cmp_gt_u32 s3, 4
    s_cselect_b32 s43, s64, s83
    s_nop 0
    s_add_u32 s43, s43, 10240
    buffer_load_dwordx4 a[16:19], v43, s[28:31], s43 offen offset:0 sc1
    v_pk_mul_f32 v[128:129], v[128:129], v[216:217]
    v_pk_mul_f32 v[130:131], v[130:131], v[218:219]
    v_pk_mul_f32 v[132:133], v[132:133], v[220:221]
    v_pk_mul_f32 v[134:135], v[134:135], v[222:223]
    buffer_load_dwordx4 a[20:23], v43, s[28:31], s43 offen offset:1024 sc1
    v_cvt_pk_bf16_f32 v120, -v120, -v121
    v_cvt_pk_bf16_f32 v121, -v122, -v123
    v_cvt_pk_bf16_f32 v122, -v124, -v125
    v_cvt_pk_bf16_f32 v123, -v126, -v127
    s_cmp_gt_u32 s3, 6
    s_cselect_b32 s43, s64, s83
    s_add_u32 s43, s43, 12288
    buffer_load_dwordx4 a[24:27], v43, s[28:31], s43 offen offset:0 sc1
    v_cvt_pk_bf16_f32 v124, -v128, -v129
    v_cvt_pk_bf16_f32 v125, -v130, -v131
    v_cvt_pk_bf16_f32 v126, -v132, -v133
    v_cvt_pk_bf16_f32 v127, -v134, -v135
    buffer_load_dwordx4 a[28:31], v43, s[28:31], s43 offen offset:1024 sc1
    ds_write_b128 v26, v[120:123] offset:0
    ds_write_b128 v27, v[124:127] offset:0
    s_waitcnt lgkmcnt(0)
    s_barrier
    ds_read_b64_tr_b16 v[112:113], v101 offset:16384
    ds_read_b64_tr_b16 v[114:115], v102 offset:16384
    ds_read_b64_tr_b16 v[116:117], v101 offset:18432
    ds_read_b64_tr_b16 v[118:119], v102 offset:18432
    ds_read_b64_tr_b16 v[128:129], v101 offset:0
    ds_read_b64_tr_b16 v[130:131], v102 offset:0
    ds_read_b64_tr_b16 v[132:133], v101 offset:2048
    ds_read_b64_tr_b16 v[134:135], v102 offset:2048
    ds_read_b128 v[208:211], v100 offset:0
    ds_read_b128 v[212:215], v100 offset:128
    ds_read_b128 v[216:219], v100 offset:16
    ds_read_b128 v[220:223], v100 offset:144
    s_lshl_b32 s49, s40, 11
    s_add_u32 s49, s49, s82
    s_add_u32 s50, s49, 8192
    s_mov_b32 s65, s49
    s_waitcnt lgkmcnt(10)
    buffer_store_dwordx4 v[112:115], v43, s[28:31], s49 offen offset:0 sc1
    ds_read_b64_tr_b16 v[168:169], v2 offset:12288
    ds_read_b64_tr_b16 v[170:171], v2 offset:13312
    ds_read_b64_tr_b16 v[172:173], v3 offset:12288
    s_waitcnt lgkmcnt(11)
    buffer_store_dwordx4 v[116:119], v43, s[28:31], s49 offen offset:1024 sc1
    ds_read_b64_tr_b16 v[174:175], v3 offset:13312
    ds_read_b64_tr_b16 v[176:177], v4 offset:12288
    ds_read_b64_tr_b16 v[178:179], v4 offset:13312
    s_waitcnt lgkmcnt(12)
    buffer_store_dwordx4 v[128:131], v43, s[28:31], s50 offen offset:0 sc1
    ds_read_b64_tr_b16 v[180:181], v5 offset:12288
    ds_read_b64_tr_b16 v[182:183], v5 offset:13312
    ds_read_b64_tr_b16 v[188:189], v11 offset:12288
    s_waitcnt lgkmcnt(13)
    buffer_store_dwordx4 v[132:135], v43, s[28:31], s50 offen offset:1024 sc1
    ds_read_b64_tr_b16 v[190:191], v11 offset:13312
    ds_read_b64_tr_b16 v[192:193], v12 offset:12288
    s_waitcnt lgkmcnt(11)
    s_waitcnt vmcnt(11)
    s_waitcnt lgkmcnt(9)
    v_mfma_f32_32x32x16_bf16 v[48:63], a[0:3], v[168:171], v[48:63]
    s_cmp_gt_u32 s3, 8
    s_cselect_b32 s43, s64, s83
    s_add_u32 s43, s43, 14336
    buffer_load_dwordx4 a[32:35], v43, s[28:31], s43 offen offset:0 sc1
    ds_read_b64_tr_b16 v[194:195], v12 offset:13312
    ds_read_b64_tr_b16 v[196:197], v13 offset:12288
    ds_read_b64_tr_b16 v[198:199], v13 offset:13312
    s_waitcnt lgkmcnt(10)
    v_mfma_f32_32x32x16_bf16 v[64:79], a[0:3], v[172:175], v[64:79]
    ds_read_b64_tr_b16 v[104:105], v2 offset:16384
    ds_read_b64_tr_b16 v[106:107], v2 offset:17408
    ds_read_b64_tr_b16 v[108:109], v3 offset:16384
    s_waitcnt lgkmcnt(11)
    v_mfma_f32_32x32x16_bf16 v[80:95], a[0:3], v[176:179], v[80:95]
    ds_read_b64_tr_b16 v[110:111], v3 offset:17408
    ds_read_b64_tr_b16 v[120:121], v4 offset:16384
    ds_read_b64_tr_b16 v[122:123], v4 offset:17408
    s_waitcnt lgkmcnt(12)
    v_mfma_f32_32x32x16_bf16 v[240:255], a[0:3], v[180:183], v[240:255]
    ds_read_b64_tr_b16 v[124:125], v5 offset:16384
    ds_read_b64_tr_b16 v[126:127], v5 offset:17408
    v_lshlrev_b32 v224, 16, v224
    s_waitcnt vmcnt(11)
    s_waitcnt lgkmcnt(12)
    v_mfma_f32_32x32x16_bf16 v[64:79], a[4:7], v[188:191], v[64:79]
    buffer_load_dwordx4 a[36:39], v43, s[28:31], s43 offen offset:1024 sc1
    ds_read_b64_tr_b16 v[168:169], v2 offset:20480
    ds_read_b64_tr_b16 v[170:171], v2 offset:21504
    ds_read_b64_tr_b16 v[172:173], v3 offset:20480
    s_waitcnt lgkmcnt(13)
    v_mfma_f32_32x32x16_bf16 v[80:95], a[4:7], v[192:195], v[80:95]
    ds_read_b64_tr_b16 v[174:175], v3 offset:21504
    ds_read_b64_tr_b16 v[176:177], v4 offset:20480
    v_lshlrev_b32_e64 v225, 16, v225
    s_waitcnt lgkmcnt(13)
    v_mfma_f32_32x32x16_bf16 v[240:255], a[4:7], v[196:199], v[240:255]
    ds_read_b64_tr_b16 v[178:179], v4 offset:21504
    ds_read_b64_tr_b16 v[180:181], v5 offset:20480
    v_mul_f32_e64 v224, v224, v29
    s_waitcnt vmcnt(11)
    s_waitcnt lgkmcnt(13)
    v_mfma_f32_32x32x16_bf16 v[48:63], a[8:11], v[104:107], v[48:63]
    s_cmp_gt_u32 s3, 10
    s_cselect_b32 s43, s64, s83
    s_add_u32 s43, s43, 16384
    buffer_load_dwordx4 a[40:43], v43, s[28:31], s43 offen offset:0 sc1
    ds_read_b64_tr_b16 v[182:183], v5 offset:21504
    ds_read_b64_tr_b16 v[184:185], v2 offset:24576
    v_mul_f32 v225, v225, v29
    s_waitcnt lgkmcnt(13)
    v_mfma_f32_32x32x16_bf16 v[64:79], a[8:11], v[108:111], v[64:79]
    ds_read_b64_tr_b16 v[186:187], v2 offset:25600
    ds_read_b64_tr_b16 v[188:189], v3 offset:24576
    v_cvt_pk_bf16_f32 v224, v224, v225
    s_waitcnt lgkmcnt(13)
    v_mfma_f32_32x32x16_bf16 v[80:95], a[8:11], v[120:123], v[80:95]
    ds_read_b64_tr_b16 v[190:191], v3 offset:25600
    ds_read_b64_tr_b16 v[192:193], v4 offset:24576
    v_and_b32_e64 v225, s42, v224
    s_waitcnt lgkmcnt(13)
    v_mfma_f32_32x32x16_bf16 v[240:255], a[8:11], v[124:127], v[240:255]
    ds_read_b64_tr_b16 v[194:195], v4 offset:25600
    ds_read_b64_tr_b16 v[196:197], v5 offset:24576
    v_lshlrev_b32 v224, 16, v224
    s_waitcnt vmcnt(3)
    s_mov_b64 exec, 1
    buffer_store_dword v45, off, s[28:31], s71 sc1
    s_mov_b64 exec, -1
    s_nop 1
    s_waitcnt lgkmcnt(13)
    v_mfma_f32_32x32x16_bf16 v[48:63], a[12:15], v[168:171], v[48:63]
    buffer_load_dwordx4 a[44:47], v43, s[28:31], s43 offen offset:1024 sc1
    ds_read_b64_tr_b16 v[198:199], v5 offset:25600
    ds_read_b64_tr_b16 v[104:105], v2 offset:28672
    v_lshlrev_b32 v226, 16, v226
    s_waitcnt lgkmcnt(13)
    v_mfma_f32_32x32x16_bf16 v[64:79], a[12:15], v[172:175], v[64:79]
    ds_read_b64_tr_b16 v[106:107], v2 offset:29696
    ds_read_b64_tr_b16 v[108:109], v3 offset:28672
    v_lshlrev_b32 v227, 16, v227
    s_waitcnt lgkmcnt(13)
    v_mfma_f32_32x32x16_bf16 v[80:95], a[12:15], v[176:179], v[80:95]
    ds_read_b64_tr_b16 v[110:111], v3 offset:29696
    ds_read_b64_tr_b16 v[120:121], v4 offset:28672
    v_mul_f32 v226, v226, v29
    s_waitcnt lgkmcnt(13)
    v_mfma_f32_32x32x16_bf16 v[240:255], a[12:15], v[180:183], v[240:255]
    ds_read_b64_tr_b16 v[122:123], v4 offset:29696
    ds_read_b64_tr_b16 v[124:125], v5 offset:28672
    v_mul_f32 v227, v227, v29
    s_waitcnt lgkmcnt(13)
    v_mfma_f32_32x32x16_bf16 v[48:63], a[16:19], v[184:187], v[48:63]
    s_cmp_gt_u32 s3, 12
    s_cselect_b32 s43, s64, s83
    s_add_u32 s43, s43, 18432
    buffer_load_dwordx4 a[48:51], v43, s[28:31], s43 offen offset:0 sc1
    ds_read_b64_tr_b16 v[126:127], v5 offset:29696
    ds_read_b64_tr_b16 v[172:173], v11 offset:16384
    v_cvt_pk_bf16_f32 v226, v226, v227
    s_waitcnt lgkmcnt(13)
    v_mfma_f32_32x32x16_bf16 v[64:79], a[16:19], v[188:191], v[64:79]
    ds_read_b64_tr_b16 v[174:175], v11 offset:17408
    ds_read_b64_tr_b16 v[176:177], v12 offset:16384
    v_and_b32_e64 v227, s42, v226
    s_waitcnt lgkmcnt(13)
    v_mfma_f32_32x32x16_bf16 v[80:95], a[16:19], v[192:195], v[80:95]
    ds_read_b64_tr_b16 v[178:179], v12 offset:17408
    ds_read_b64_tr_b16 v[180:181], v13 offset:16384
    v_lshlrev_b32 v226, 16, v226
    s_waitcnt lgkmcnt(13)
    v_mfma_f32_32x32x16_bf16 v[240:255], a[16:19], v[196:199], v[240:255]
    ds_read_b64_tr_b16 v[182:183], v13 offset:17408
    v_lshlrev_b32 v228, 16, v228
    v_lshlrev_b32 v229, 16, v229
    s_waitcnt lgkmcnt(0)
    v_mfma_f32_32x32x16_bf16 v[48:63], a[20:23], v[104:107], v[48:63]
    s_barrier
    buffer_load_dwordx4 a[52:55], v43, s[28:31], s43 offen offset:1024 sc1
    ds_read_b64_tr_b16 v[188:189], v11 offset:20480
    ds_read_b64_tr_b16 v[190:191], v11 offset:21504
    ds_read_b64_tr_b16 v[192:193], v12 offset:20480
    v_mfma_f32_32x32x16_bf16 v[64:79], a[20:23], v[108:111], v[64:79]
    ds_read_b64_tr_b16 v[194:195], v12 offset:21504
    ds_read_b64_tr_b16 v[196:197], v13 offset:20480
    ds_read_b64_tr_b16 v[198:199], v13 offset:21504
    v_mfma_f32_32x32x16_bf16 v[80:95], a[20:23], v[120:123], v[80:95]
    v_mul_f32 v228, v228, v29
    v_mul_f32 v229, v229, v29
    v_cvt_pk_bf16_f32 v228, v228, v229
    v_mfma_f32_32x32x16_bf16 v[240:255], a[20:23], v[124:127], v[240:255]
    v_and_b32 v229, s42, v228
    v_lshlrev_b32 v228, 16, v228
    v_lshlrev_b32_e64 v230, 16, v230
    v_mfma_f32_32x32x16_bf16 v[64:79], a[24:27], v[172:175], v[64:79]
    s_cmp_gt_u32 s3, 14
    s_cselect_b32 s43, s64, s83
    s_add_u32 s43, s43, 20480
    buffer_load_dwordx4 a[56:59], v43, s[28:31], s43 offen offset:0 sc1
    ds_read_b64_tr_b16 v[108:109], v11 offset:24576
    ds_read_b64_tr_b16 v[110:111], v11 offset:25600
    ds_read_b64_tr_b16 v[120:121], v12 offset:24576
    v_mfma_f32_32x32x16_bf16 v[80:95], a[24:27], v[176:179], v[80:95]
    ds_read_b64_tr_b16 v[122:123], v12 offset:25600
    ds_read_b64_tr_b16 v[124:125], v13 offset:24576
    ds_read_b64_tr_b16 v[126:127], v13 offset:25600
    v_mfma_f32_32x32x16_bf16 v[240:255], a[24:27], v[180:183], v[240:255]
    v_lshlrev_b32 v231, 16, v231
    v_mul_f32 v230, v230, v29
    v_mul_f32 v231, v231, v29
    s_waitcnt lgkmcnt(10)
    v_mfma_f32_32x32x16_bf16 v[64:79], a[28:31], v[188:191], v[64:79]
    buffer_load_dwordx4 a[60:63], v43, s[28:31], s43 offen offset:1024 sc1
    ds_read_b64_tr_b16 v[172:173], v11 offset:28672
    ds_read_b64_tr_b16 v[174:175], v11 offset:29696
    ds_read_b64_tr_b16 v[176:177], v12 offset:28672
    s_waitcnt lgkmcnt(11)
    v_mfma_f32_32x32x16_bf16 v[80:95], a[28:31], v[192:195], v[80:95]
    ds_read_b64_tr_b16 v[178:179], v12 offset:29696
    ds_read_b64_tr_b16 v[180:181], v13 offset:28672
    ds_read_b64_tr_b16 v[182:183], v13 offset:29696
    s_waitcnt lgkmcnt(12)
    v_mfma_f32_32x32x16_bf16 v[240:255], a[28:31], v[196:199], v[240:255]
    v_cvt_pk_bf16_f32 v230, v230, v231
    v_and_b32 v231, s42, v230
    v_lshlrev_b32 v230, 16, v230
    s_waitcnt vmcnt(8)
    s_waitcnt lgkmcnt(10)
    v_mfma_f32_32x32x16_bf16 v[64:79], a[32:35], v[108:111], v[64:79]
    s_cmp_gt_u32 s3, 16
    s_cselect_b32 s43, s64, s83
    s_add_u32 s43, s43, 22528
    buffer_load_dwordx4 a[64:67], v43, s[28:31], s43 offen offset:0 sc1
    ds_read_b64_tr_b16 v[188:189], v3 offset:32768
    ds_read_b64_tr_b16 v[190:191], v3 offset:33792
    ds_read_b64_tr_b16 v[192:193], v4 offset:32768
    s_waitcnt lgkmcnt(11)
    v_mfma_f32_32x32x16_bf16 v[80:95], a[32:35], v[120:123], v[80:95]
    ds_read_b64_tr_b16 v[194:195], v4 offset:33792
    ds_read_b64_tr_b16 v[196:197], v5 offset:32768
    ds_read_b64_tr_b16 v[198:199], v5 offset:33792
    s_waitcnt lgkmcnt(12)
    v_mfma_f32_32x32x16_bf16 v[240:255], a[32:35], v[124:127], v[240:255]
    v_lshlrev_b32 v232, 16, v232
    v_lshlrev_b32 v233, 16, v233
    v_mul_f32_e64 v232, v232, v29
    s_waitcnt vmcnt(8)
    s_waitcnt lgkmcnt(10)
    v_mfma_f32_32x32x16_bf16 v[64:79], a[36:39], v[172:175], v[64:79]
    buffer_load_dwordx4 a[68:71], v43, s[28:31], s43 offen offset:1024 sc1
    ds_read_b64_tr_b16 v[108:109], v3 offset:36864
    ds_read_b64_tr_b16 v[110:111], v3 offset:37888
    ds_read_b64_tr_b16 v[120:121], v4 offset:36864
    s_waitcnt lgkmcnt(11)
    v_mfma_f32_32x32x16_bf16 v[80:95], a[36:39], v[176:179], v[80:95]
    ds_read_b64_tr_b16 v[122:123], v4 offset:37888
    ds_read_b64_tr_b16 v[124:125], v5 offset:36864
    ds_read_b64_tr_b16 v[126:127], v5 offset:37888
    s_waitcnt lgkmcnt(12)
    v_mfma_f32_32x32x16_bf16 v[240:255], a[36:39], v[180:183], v[240:255]
    v_mul_f32 v233, v233, v29
    v_cvt_pk_bf16_f32 v232, v232, v233
    v_and_b32 v233, s42, v232
    buffer_load_dword v97, v28, s[28:31], s44 offen sc1
    s_add_u32 m0, s46, 131072
    s_xor_b32 s52, s61, 128
    buffer_load_dwordx4 v6, s[20:23], s52 offen offset:0 lds
    s_waitcnt vmcnt(10)
    s_waitcnt lgkmcnt(10)
    v_mfma_f32_32x32x16_bf16 v[64:79], a[40:43], v[188:191], v[64:79]
    s_cmp_gt_u32 s3, 18
    s_cselect_b32 s43, s64, s83
    s_add_u32 s43, s43, 24576
    buffer_load_dwordx4 a[72:75], v43, s[28:31], s43 offen offset:0 sc1
    ds_read_b64_tr_b16 v[172:173], v3 offset:40960
    ds_read_b64_tr_b16 v[174:175], v3 offset:41984
    ds_read_b64_tr_b16 v[176:177], v4 offset:40960
    s_waitcnt lgkmcnt(11)
    v_mfma_f32_32x32x16_bf16 v[80:95], a[40:43], v[192:195], v[80:95]
    ds_read_b64_tr_b16 v[178:179], v4 offset:41984
    ds_read_b64_tr_b16 v[180:181], v5 offset:40960
    ds_read_b64_tr_b16 v[182:183], v5 offset:41984
    s_waitcnt lgkmcnt(12)
    v_mfma_f32_32x32x16_bf16 v[240:255], a[40:43], v[196:199], v[240:255]
    v_lshlrev_b32 v232, 16, v232
    v_lshlrev_b32 v234, 16, v234
    v_lshlrev_b32_e64 v235, 16, v235
    s_waitcnt vmcnt(9)
    s_waitcnt lgkmcnt(10)
    v_mfma_f32_32x32x16_bf16 v[64:79], a[44:47], v[108:111], v[64:79]
    buffer_load_dwordx4 a[76:79], v43, s[28:31], s43 offen offset:1024 sc1
    ds_read_b64_tr_b16 v[188:189], v3 offset:45056
    ds_read_b64_tr_b16 v[190:191], v3 offset:46080
    ds_read_b64_tr_b16 v[192:193], v4 offset:45056
    s_waitcnt lgkmcnt(11)
    v_mfma_f32_32x32x16_bf16 v[80:95], a[44:47], v[120:123], v[80:95]
    ds_read_b64_tr_b16 v[194:195], v4 offset:46080
    ds_read_b64_tr_b16 v[196:197], v5 offset:45056
    ds_read_b64_tr_b16 v[198:199], v5 offset:46080
    s_waitcnt lgkmcnt(12)
    v_mfma_f32_32x32x16_bf16 v[240:255], a[44:47], v[124:127], v[240:255]
    v_mul_f32 v234, v234, v29
    v_mul_f32 v235, v235, v29
    v_cvt_pk_bf16_f32 v234, v234, v235
    buffer_load_dwordx4 v7, s[20:23], s52 offen offset:1024 lds
    s_waitcnt vmcnt(10)
    s_waitcnt lgkmcnt(10)
    v_mfma_f32_32x32x16_bf16 v[64:79], a[48:51], v[172:175], v[64:79]
    s_cmp_gt_u32 s3, 20
    s_cselect_b32 s43, s64, s83
    s_add_u32 s43, s43, 26624
    buffer_load_dwordx4 a[80:83], v43, s[28:31], s43 offen offset:0 sc1
    ds_read_b64_tr_b16 v[108:109], v11 offset:32768
    ds_read_b64_tr_b16 v[110:111], v11 offset:33792
    ds_read_b64_tr_b16 v[120:121], v12 offset:32768
    s_waitcnt lgkmcnt(11)
    v_mfma_f32_32x32x16_bf16 v[80:95], a[48:51], v[176:179], v[80:95]
    ds_read_b64_tr_b16 v[122:123], v12 offset:33792
    ds_read_b64_tr_b16 v[124:125], v13 offset:32768
    ds_read_b64_tr_b16 v[126:127], v13 offset:33792
    s_waitcnt lgkmcnt(12)
    v_mfma_f32_32x32x16_bf16 v[240:255], a[48:51], v[180:183], v[240:255]
    v_and_b32 v235, s42, v234
    v_lshlrev_b32 v234, 16, v234
    v_lshlrev_b32_e64 v236, 16, v236
    s_waitcnt vmcnt(10)
    s_waitcnt lgkmcnt(10)
    v_mfma_f32_32x32x16_bf16 v[64:79], a[52:55], v[188:191], v[64:79]
    buffer_load_dwordx4 a[84:87], v43, s[28:31], s43 offen offset:1024 sc1
    ds_read_b64_tr_b16 v[172:173], v11 offset:36864
    ds_read_b64_tr_b16 v[174:175], v11 offset:37888
    ds_read_b64_tr_b16 v[176:177], v12 offset:36864
    s_waitcnt lgkmcnt(11)
    v_mfma_f32_32x32x16_bf16 v[80:95], a[52:55], v[192:195], v[80:95]
    ds_read_b64_tr_b16 v[178:179], v12 offset:37888
    ds_read_b64_tr_b16 v[180:181], v13 offset:36864
    ds_read_b64_tr_b16 v[182:183], v13 offset:37888
    s_waitcnt lgkmcnt(12)
    v_mfma_f32_32x32x16_bf16 v[240:255], a[52:55], v[196:199], v[240:255]
    v_lshlrev_b32 v237, 16, v237
    v_mul_f32 v236, v236, v29
    v_mul_f32_e64 v237, v237, v29
    buffer_load_dwordx4 v8, s[20:23], s52 offen offset:2048 lds
    s_waitcnt vmcnt(11)
    s_waitcnt lgkmcnt(10)
    v_mfma_f32_32x32x16_bf16 v[64:79], a[56:59], v[108:111], v[64:79]
    s_waitcnt vmcnt(7)
    s_mov_b32 s60, 0
L_f1_chk:
    v_cmp_ne_u32 vcc, s41, v97
    s_add_u32 s60, s60, 1
    s_cbranch_vccz L_f1_ok
    s_cmp_ge_u32 s60, 0x8000
    s_cbranch_scc1 L_f1_ok
    buffer_load_dword v97, v28, s[28:31], s44 offen sc1
    s_waitcnt vmcnt(0)
    s_branch L_f1_chk
L_f1_ok:
    s_xor_b32 s43, s40, 1
    s_lshl_b32 s43, s43, 11
    s_add_u32 s43, s43, s82
    buffer_load_dwordx4 a[88:91], v43, s[28:31], s43 offen offset:0 sc1
    buffer_load_dwordx4 a[92:95], v43, s[28:31], s43 offen offset:1024 sc1
    ds_read_b64_tr_b16 v[188:189], v11 offset:40960
    ds_read_b64_tr_b16 v[190:191], v11 offset:41984
    ds_read_b64_tr_b16 v[192:193], v12 offset:40960
    s_waitcnt lgkmcnt(11)
    v_mfma_f32_32x32x16_bf16 v[80:95], a[56:59], v[120:123], v[80:95]
    ds_read_b64_tr_b16 v[194:195], v12 offset:41984
    ds_read_b64_tr_b16 v[196:197], v13 offset:40960
    ds_read_b64_tr_b16 v[198:199], v13 offset:41984
    s_waitcnt lgkmcnt(12)
    v_mfma_f32_32x32x16_bf16 v[240:255], a[56:59], v[124:127], v[240:255]
    v_cvt_pk_bf16_f32 v236, v236, v237
    v_and_b32 v237, s42, v236
    v_lshlrev_b32_e64 v236, 16, v236
    s_waitcnt lgkmcnt(10)
    v_mfma_f32_32x32x16_bf16 v[64:79], a[60:63], v[172:175], v[64:79]
    s_xor_b32 s43, s40, 2
    s_lshl_b32 s43, s43, 11
    s_add_u32 s43, s43, s82
    buffer_load_dwordx4 a[96:99], v43, s[28:31], s43 offen offset:0 sc1
    buffer_load_dwordx4 a[100:103], v43, s[28:31], s43 offen offset:1024 sc1
    ds_read_b64_tr_b16 v[108:109], v11 offset:45056
    ds_read_b64_tr_b16 v[110:111], v11 offset:46080
    ds_read_b64_tr_b16 v[120:121], v12 offset:45056
    s_waitcnt lgkmcnt(11)
    v_mfma_f32_32x32x16_bf16 v[80:95], a[60:63], v[176:179], v[80:95]
    ds_read_b64_tr_b16 v[122:123], v12 offset:46080
    ds_read_b64_tr_b16 v[124:125], v13 offset:45056
    ds_read_b64_tr_b16 v[126:127], v13 offset:46080
    s_waitcnt lgkmcnt(12)
    v_mfma_f32_32x32x16_bf16 v[240:255], a[60:63], v[180:183], v[240:255]
    v_lshlrev_b32 v238, 16, v238
    v_lshlrev_b32 v239, 16, v239
    v_mul_f32_e64 v238, v238, v29
    buffer_load_dwordx4 v9, s[20:23], s52 offen offset:3072 lds
    s_waitcnt lgkmcnt(10)
    v_mfma_f32_32x32x16_bf16 v[64:79], a[64:67], v[188:191], v[64:79]
    s_xor_b32 s43, s40, 3
    s_lshl_b32 s43, s43, 11
    s_add_u32 s43, s43, s82
    buffer_load_dwordx4 a[104:107], v43, s[28:31], s43 offen offset:0 sc1
    buffer_load_dwordx4 a[108:111], v43, s[28:31], s43 offen offset:1024 sc1
    ds_read_b64_tr_b16 v[172:173], v11 offset:49152
    ds_read_b64_tr_b16 v[174:175], v11 offset:50176
    ds_read_b64_tr_b16 v[176:177], v12 offset:49152
    s_waitcnt lgkmcnt(11)
    v_mfma_f32_32x32x16_bf16 v[80:95], a[64:67], v[192:195], v[80:95]
    ds_read_b64_tr_b16 v[178:179], v12 offset:50176
    ds_read_b64_tr_b16 v[180:181], v13 offset:49152
    ds_read_b64_tr_b16 v[182:183], v13 offset:50176
    s_waitcnt lgkmcnt(12)
    v_mfma_f32_32x32x16_bf16 v[240:255], a[64:67], v[196:199], v[240:255]
    v_mul_f32 v239, v239, v29
    v_cvt_pk_bf16_f32 v238, v238, v239
    v_and_b32 v239, s42, v238
    s_waitcnt lgkmcnt(10)
    v_mfma_f32_32x32x16_bf16 v[64:79], a[68:71], v[108:111], v[64:79]
    s_xor_b32 s43, s40, 1
    s_lshl_b32 s43, s43, 11
    s_add_u32 s43, s43, s82
    s_add_u32 s43, s43, 8192
    buffer_load_dwordx4 a[112:115], v43, s[28:31], s43 offen offset:0 sc1
    buffer_load_dwordx4 a[116:119], v43, s[28:31], s43 offen offset:1024 sc1
    ds_read_b64_tr_b16 v[188:189], v11 offset:53248
    ds_read_b64_tr_b16 v[190:191], v11 offset:54272
    ds_read_b64_tr_b16 v[192:193], v12 offset:53248
    s_waitcnt lgkmcnt(11)
    v_mfma_f32_32x32x16_bf16 v[80:95], a[68:71], v[120:123], v[80:95]
    ds_read_b64_tr_b16 v[194:195], v12 offset:54272
    ds_read_b64_tr_b16 v[196:197], v13 offset:53248
    ds_read_b64_tr_b16 v[198:199], v13 offset:54272
    s_waitcnt lgkmcnt(12)
    v_mfma_f32_32x32x16_bf16 v[240:255], a[68:71], v[124:127], v[240:255]
    v_lshlrev_b32_e64 v238, 16, v238
    v_fma_f32 v48, v224, v208, v48
    v_fma_f32 v49, v225, v209, v49
    s_add_u32 m0, s46, 0
    s_nop 0
    buffer_load_dwordx4 v6, s[24:27], s61 offen offset:0 lds
    s_waitcnt vmcnt(15)
    s_waitcnt lgkmcnt(10)
    v_mfma_f32_32x32x16_bf16 v[64:79], a[72:75], v[172:175], v[64:79]
    s_xor_b32 s43, s40, 2
    s_lshl_b32 s43, s43, 11
    s_add_u32 s43, s43, s82
    s_add_u32 s43, s43, 8192
    buffer_load_dwordx4 a[120:123], v43, s[28:31], s43 offen offset:0 sc1
    buffer_load_dwordx4 a[124:127], v43, s[28:31], s43 offen offset:1024 sc1
    ds_read_b64_tr_b16 v[108:109], v11 offset:57344
    ds_read_b64_tr_b16 v[110:111], v11 offset:58368
    ds_read_b64_tr_b16 v[120:121], v12 offset:57344
    s_waitcnt lgkmcnt(11)
    v_mfma_f32_32x32x16_bf16 v[80:95], a[72:75], v[176:179], v[80:95]
    ds_read_b64_tr_b16 v[122:123], v12 offset:58368
    ds_read_b64_tr_b16 v[124:125], v13 offset:57344
    ds_read_b64_tr_b16 v[126:127], v13 offset:58368
    s_waitcnt lgkmcnt(12)
    v_mfma_f32_32x32x16_bf16 v[240:255], a[72:75], v[180:183], v[240:255]
    v_fma_f32 v50, v226, v210, v50
    v_fma_f32 v51, v227, v211, v51
    v_fma_f32 v52, v228, v212, v52
    buffer_load_dwordx4 v7, s[24:27], s61 offen offset:1024 lds
    s_waitcnt vmcnt(17)
    s_waitcnt lgkmcnt(10)
    v_mfma_f32_32x32x16_bf16 v[64:79], a[76:79], v[188:191], v[64:79]
    s_xor_b32 s43, s40, 3
    s_lshl_b32 s43, s43, 11
    s_add_u32 s43, s43, s82
    s_add_u32 s43, s43, 8192
    buffer_load_dwordx4 a[128:131], v43, s[28:31], s43 offen offset:0 sc1
    buffer_load_dwordx4 a[132:135], v43, s[28:31], s43 offen offset:1024 sc1
    ds_read_b64_tr_b16 v[172:173], v11 offset:61440
    ds_read_b64_tr_b16 v[174:175], v11 offset:62464
    ds_read_b64_tr_b16 v[176:177], v12 offset:61440
    s_waitcnt lgkmcnt(11)
    v_mfma_f32_32x32x16_bf16 v[80:95], a[76:79], v[192:195], v[80:95]
    ds_read_b64_tr_b16 v[178:179], v12 offset:62464
    ds_read_b64_tr_b16 v[180:181], v13 offset:61440
    ds_read_b64_tr_b16 v[182:183], v13 offset:62464
    s_waitcnt lgkmcnt(12)
    v_mfma_f32_32x32x16_bf16 v[240:255], a[76:79], v[196:199], v[240:255]
    v_fma_f32 v53, v229, v213, v53
    v_fma_f32 v54, v230, v214, v54
    v_fma_f32 v55, v231, v215, v55
    buffer_load_dwordx4 v8, s[24:27], s61 offen offset:2048 lds
    s_waitcnt vmcnt(18)
    s_waitcnt lgkmcnt(10)
    v_mfma_f32_32x32x16_bf16 v[64:79], a[80:83], v[108:111], v[64:79]
    ds_read_b128 v[188:191], v18 offset:53248
    ds_read_b128 v[192:195], v18 offset:57344
    ds_read_b128 v[196:199], v18 offset:61440
    s_waitcnt lgkmcnt(11)
    v_mfma_f32_32x32x16_bf16 v[80:95], a[80:83], v[120:123], v[80:95]
    v_fma_f32 v56, v232, v216, v56
    v_fma_f32 v57, v233, v217, v57
    v_fma_f32 v58, v234, v218, v58
    s_waitcnt lgkmcnt(9)
    v_mfma_f32_32x32x16_bf16 v[240:255], a[80:83], v[124:127], v[240:255]
    v_fma_f32 v59, v235, v219, v59
    v_fma_f32 v60, v236, v220, v60
    v_fma_f32 v61, v237, v221, v61
    buffer_load_dwordx4 v9, s[24:27], s61 offen offset:3072 lds
    s_waitcnt vmcnt(18)
    s_waitcnt lgkmcnt(7)
    v_mfma_f32_32x32x16_bf16 v[64:79], a[84:87], v[172:175], v[64:79]
    ds_read_b128 v[108:111], v19 offset:53248
    ds_read_b128 v[120:123], v19 offset:57344
    ds_read_b128 v[124:127], v19 offset:61440
    s_waitcnt lgkmcnt(8)
    v_mfma_f32_32x32x16_bf16 v[80:95], a[84:87], v[176:179], v[80:95]
    v_fma_f32 v62, v238, v222, v62
    v_fma_f32 v63, v239, v223, v63
    s_waitcnt lgkmcnt(6)
    v_mfma_f32_32x32x16_bf16 v[240:255], a[84:87], v[180:183], v[240:255]
    s_add_u32 m0, s46, 16384
    s_xor_b32 s52, s61, 128
    buffer_load_dwordx4 v6, s[24:27], s52 offen offset:0 lds
    s_waitcnt lgkmcnt(5)
    v_mfma_f32_32x32x16_bf16 v[64:79], v[112:115], v[188:191], v[64:79]
    ds_read_b128 v[172:175], v20 offset:53248
    ds_read_b128 v[176:179], v20 offset:57344
    ds_read_b128 v[180:183], v20 offset:61440
    s_waitcnt lgkmcnt(7)
    v_mfma_f32_32x32x16_bf16 v[80:95], v[112:115], v[192:195], v[80:95]
    s_waitcnt lgkmcnt(6)
    v_mfma_f32_32x32x16_bf16 v[240:255], v[112:115], v[196:199], v[240:255]
    buffer_load_dwordx4 v7, s[24:27], s52 offen offset:1024 lds
    s_waitcnt lgkmcnt(5)
    v_mfma_f32_32x32x16_bf16 v[64:79], v[116:119], v[108:111], v[64:79]
    ds_read_b128 v[188:191], v21 offset:53248
    ds_read_b128 v[192:195], v21 offset:57344
    ds_read_b128 v[196:199], v21 offset:61440
    s_waitcnt lgkmcnt(7)
    v_mfma_f32_32x32x16_bf16 v[80:95], v[116:119], v[120:123], v[80:95]
    s_waitcnt lgkmcnt(6)
    v_mfma_f32_32x32x16_bf16 v[240:255], v[116:119], v[124:127], v[240:255]
    buffer_load_dwordx4 v8, s[24:27], s52 offen offset:2048 lds
    s_waitcnt vmcnt(19)
    s_waitcnt lgkmcnt(0)
    v_mfma_f32_32x32x16_bf16 v[64:79], a[88:91], v[172:175], v[64:79]
    s_waitcnt vmcnt(15)
    s_barrier
    ds_read_b128 v[108:111], v22 offset:4096
    ds_read_b128 v[120:123], v22 offset:8192
    ds_read_b128 v[124:127], v22 offset:12288
    v_mfma_f32_32x32x16_bf16 v[80:95], a[88:91], v[176:179], v[80:95]
    v_mfma_f32_32x32x16_bf16 v[240:255], a[88:91], v[180:183], v[240:255]
    buffer_load_dwordx4 v9, s[24:27], s52 offen offset:3072 lds
    v_mfma_f32_32x32x16_bf16 v[64:79], a[92:95], v[188:191], v[64:79]
    ds_read_b128 v[172:175], v23 offset:4096
    ds_read_b128 v[176:179], v23 offset:8192
    ds_read_b128 v[180:183], v23 offset:12288
    v_mfma_f32_32x32x16_bf16 v[80:95], a[92:95], v[192:195], v[80:95]
    v_mfma_f32_32x32x16_bf16 v[240:255], a[92:95], v[196:199], v[240:255]
    s_waitcnt lgkmcnt(5)
    v_mfma_f32_32x32x16_bf16 v[64:79], a[96:99], v[108:111], v[64:79]
    ds_read_b128 v[188:191], v24 offset:4096
    ds_read_b128 v[192:195], v24 offset:8192
    ds_read_b128 v[196:199], v24 offset:12288
    s_waitcnt lgkmcnt(7)
    v_mfma_f32_32x32x16_bf16 v[80:95], a[96:99], v[120:123], v[80:95]
    s_waitcnt lgkmcnt(6)
    v_mfma_f32_32x32x16_bf16 v[240:255], a[96:99], v[124:127], v[240:255]
    s_waitcnt lgkmcnt(5)
    v_mfma_f32_32x32x16_bf16 v[64:79], a[100:103], v[172:175], v[64:79]
    ds_read_b128 v[108:111], v25 offset:4096
    ds_read_b128 v[120:123], v25 offset:8192
    ds_read_b128 v[124:127], v25 offset:12288
    s_waitcnt lgkmcnt(7)
    v_mfma_f32_32x32x16_bf16 v[80:95], a[100:103], v[176:179], v[80:95]
    s_waitcnt lgkmcnt(6)
    v_mfma_f32_32x32x16_bf16 v[240:255], a[100:103], v[180:183], v[240:255]
    s_waitcnt vmcnt(15)
    s_waitcnt lgkmcnt(0)
    v_mfma_f32_32x32x16_bf16 v[64:79], a[104:107], v[188:191], v[64:79]
    s_waitcnt vmcnt(0)
    s_barrier
    v_mfma_f32_32x32x16_bf16 v[80:95], a[104:107], v[192:195], v[80:95]
    v_mfma_f32_32x32x16_bf16 v[240:255], a[104:107], v[196:199], v[240:255]
    v_mfma_f32_32x32x16_bf16 v[64:79], a[108:111], v[108:111], v[64:79]
    v_mfma_f32_32x32x16_bf16 v[80:95], a[108:111], v[120:123], v[80:95]
    v_mfma_f32_32x32x16_bf16 v[240:255], a[108:111], v[124:127], v[240:255]
    ds_read_b128 v[168:171], v18 offset:4096
    ds_read_b128 v[172:175], v19 offset:4096
    s_branch L_pg5
.p2align 12
L_pad5:
    s_branch L_touch_ret
    s_nop 0
L_pg5:
    ds_read_b128 v[176:179], v20 offset:4096
    ds_read_b128 v[180:183], v21 offset:4096
    ds_read_b128 v[184:187], v18 offset:20480
    s_waitcnt lgkmcnt(4)
    v_mfma_f32_32x32x16_bf16 v[64:79], v[128:131], v[168:171], v[64:79]
    ds_read_b128 v[188:191], v19 offset:20480
    s_waitcnt lgkmcnt(4)
    v_mfma_f32_32x32x16_bf16 v[64:79], v[132:135], v[172:175], v[64:79]
    ds_read_b128 v[192:195], v20 offset:20480
    s_waitcnt lgkmcnt(4)
    v_mfma_f32_32x32x16_bf16 v[64:79], a[112:115], v[176:179], v[64:79]
    ds_read_b128 v[196:199], v21 offset:20480
    s_waitcnt lgkmcnt(4)
    v_mfma_f32_32x32x16_bf16 v[64:79], a[116:119], v[180:183], v[64:79]
    ds_read_b128 v[168:171], v18 offset:8192
    s_waitcnt lgkmcnt(4)
    v_mfma_f32_32x32x16_bf16 v[64:79], a[120:123], v[184:187], v[64:79]
    ds_read_b128 v[172:175], v19 offset:8192
    s_waitcnt lgkmcnt(4)
    v_mfma_f32_32x32x16_bf16 v[64:79], a[124:127], v[188:191], v[64:79]
    ds_read_b128 v[176:179], v20 offset:8192
    s_waitcnt lgkmcnt(4)
    v_mfma_f32_32x32x16_bf16 v[64:79], a[128:131], v[192:195], v[64:79]
    ds_read_b128 v[180:183], v21 offset:8192
    s_waitcnt lgkmcnt(4)
    v_mfma_f32_32x32x16_bf16 v[64:79], a[132:135], v[196:199], v[64:79]
    ds_read_b128 v[184:187], v18 offset:24576
    s_waitcnt lgkmcnt(4)
    v_mfma_f32_32x32x16_bf16 v[80:95], v[128:131], v[168:171], v[80:95]
    ds_read_b128 v[188:191], v19 offset:24576
    s_waitcnt lgkmcnt(4)
    v_mfma_f32_32x32x16_bf16 v[80:95], v[132:135], v[172:175], v[80:95]
    ds_read_b128 v[192:195], v20 offset:24576
    s_waitcnt lgkmcnt(4)
    v_mfma_f32_32x32x16_bf16 v[80:95], a[112:115], v[176:179], v[80:95]
    ds_read_b128 v[196:199], v21 offset:24576
    s_waitcnt lgkmcnt(4)
    v_mfma_f32_32x32x16_bf16 v[80:95], a[116:119], v[180:183], v[80:95]
    ds_read_b128 v[168:171], v18 offset:12288
    v_cvt_pk_bf16_f32 v64, v64, v65
    v_cvt_pk_bf16_f32 v65, v66, v67
    v_cvt_pk_bf16_f32 v66, v68, v69
    s_waitcnt lgkmcnt(4)
    v_mfma_f32_32x32x16_bf16 v[80:95], a[120:123], v[184:187], v[80:95]
    ds_read_b128 v[172:175], v19 offset:12288
    v_cvt_pk_bf16_f32 v67, v70, v71
    buffer_store_dwordx4 v[64:67], v43, s[28:31], s72 offen offset:0 sc1
    v_cvt_pk_bf16_f32 v68, v72, v73
    s_waitcnt lgkmcnt(4)
    v_mfma_f32_32x32x16_bf16 v[80:95], a[124:127], v[188:191], v[80:95]
    ds_read_b128 v[176:179], v20 offset:12288
    v_cvt_pk_bf16_f32 v69, v74, v75
    v_cvt_pk_bf16_f32 v70, v76, v77
    v_cvt_pk_bf16_f32 v71, v78, v79
    s_waitcnt lgkmcnt(4)
    v_mfma_f32_32x32x16_bf16 v[80:95], a[128:131], v[192:195], v[80:95]
    ds_read_b128 v[180:183], v21 offset:12288
    buffer_store_dwordx4 v[68:71], v43, s[28:31], s72 offen offset:1024 sc1
    s_waitcnt lgkmcnt(4)
    v_mfma_f32_32x32x16_bf16 v[80:95], a[132:135], v[196:199], v[80:95]
    ds_read_b128 v[184:187], v18 offset:28672
    s_waitcnt lgkmcnt(4)
    v_mfma_f32_32x32x16_bf16 v[240:255], v[128:131], v[168:171], v[240:255]
    ds_read_b128 v[188:191], v19 offset:28672
    s_waitcnt lgkmcnt(4)
    v_mfma_f32_32x32x16_bf16 v[240:255], v[132:135], v[172:175], v[240:255]
    ds_read_b128 v[192:195], v20 offset:28672
    s_waitcnt lgkmcnt(4)
    v_mfma_f32_32x32x16_bf16 v[240:255], a[112:115], v[176:179], v[240:255]
    ds_read_b128 v[196:199], v21 offset:28672
    s_waitcnt lgkmcnt(4)
    v_mfma_f32_32x32x16_bf16 v[240:255], a[116:119], v[180:183], v[240:255]
    ds_read_b64_tr_b16 v[168:169], v10 offset:12288
    ds_read_b64_tr_b16 v[170:171], v10 offset:13312
    v_cvt_pk_bf16_f32 v80, v80, v81
    v_cvt_pk_bf16_f32 v81, v82, v83
    v_cvt_pk_bf16_f32 v82, v84, v85
    s_waitcnt lgkmcnt(5)
    v_mfma_f32_32x32x16_bf16 v[240:255], a[120:123], v[184:187], v[240:255]
    ds_read_b64_tr_b16 v[172:173], v10 offset:16384
    ds_read_b64_tr_b16 v[174:175], v10 offset:17408
    v_cvt_pk_bf16_f32 v83, v86, v87
    buffer_store_dwordx4 v[80:83], v43, s[28:31], s73 offen offset:0 sc1
    v_cvt_pk_bf16_f32 v84, v88, v89
    s_waitcnt lgkmcnt(6)
    v_mfma_f32_32x32x16_bf16 v[240:255], a[124:127], v[188:191], v[240:255]
    ds_read_b64_tr_b16 v[176:177], v10 offset:20480
    ds_read_b64_tr_b16 v[178:179], v10 offset:21504
    v_cvt_pk_bf16_f32 v85, v90, v91
    v_cvt_pk_bf16_f32 v86, v92, v93
    v_cvt_pk_bf16_f32 v87, v94, v95
    s_waitcnt lgkmcnt(7)
    v_mfma_f32_32x32x16_bf16 v[240:255], a[128:131], v[192:195], v[240:255]
    ds_read_b64_tr_b16 v[180:181], v10 offset:24576
    ds_read_b64_tr_b16 v[182:183], v10 offset:25600
    buffer_store_dwordx4 v[84:87], v43, s[28:31], s73 offen offset:1024 sc1
    s_waitcnt lgkmcnt(8)
    v_mfma_f32_32x32x16_bf16 v[240:255], a[132:135], v[196:199], v[240:255]
    ds_read_b64_tr_b16 v[184:185], v10 offset:28672
    ds_read_b64_tr_b16 v[186:187], v10 offset:29696
    s_waitcnt lgkmcnt(8)
    v_mfma_f32_32x32x16_bf16 v[48:63], a[4:7], v[168:171], v[48:63]
    ds_read_b64_tr_b16 v[188:189], v2 offset:32768
    ds_read_b64_tr_b16 v[190:191], v2 offset:33792
    s_waitcnt lgkmcnt(8)
    v_mfma_f32_32x32x16_bf16 v[48:63], a[24:27], v[172:175], v[48:63]
    ds_read_b64_tr_b16 v[192:193], v2 offset:36864
    ds_read_b64_tr_b16 v[194:195], v2 offset:37888
    s_waitcnt lgkmcnt(8)
    v_mfma_f32_32x32x16_bf16 v[48:63], a[28:31], v[176:179], v[48:63]
    ds_read_b64_tr_b16 v[196:197], v2 offset:40960
    ds_read_b64_tr_b16 v[198:199], v2 offset:41984
    s_waitcnt lgkmcnt(8)
    v_mfma_f32_32x32x16_bf16 v[48:63], a[32:35], v[180:183], v[48:63]
    ds_read_b64_tr_b16 v[168:169], v2 offset:45056
    ds_read_b64_tr_b16 v[170:171], v2 offset:46080
    v_cvt_pk_bf16_f32 v240, v240, v241
    v_cvt_pk_bf16_f32 v241, v242, v243
    v_cvt_pk_bf16_f32 v242, v244, v245
    s_waitcnt lgkmcnt(8)
    v_mfma_f32_32x32x16_bf16 v[48:63], a[36:39], v[184:187], v[48:63]
    ds_read_b64_tr_b16 v[172:173], v10 offset:32768
    ds_read_b64_tr_b16 v[174:175], v10 offset:33792
    v_cvt_pk_bf16_f32 v243, v246, v247
    buffer_store_dwordx4 v[240:243], v43, s[28:31], s74 offen offset:0 sc1
    v_cvt_pk_bf16_f32 v244, v248, v249
    s_waitcnt lgkmcnt(8)
    v_mfma_f32_32x32x16_bf16 v[48:63], a[40:43], v[188:191], v[48:63]
    ds_read_b64_tr_b16 v[176:177], v10 offset:36864
    ds_read_b64_tr_b16 v[178:179], v10 offset:37888
    v_cvt_pk_bf16_f32 v245, v250, v251
    v_cvt_pk_bf16_f32 v246, v252, v253
    v_cvt_pk_bf16_f32 v247, v254, v255
    s_waitcnt lgkmcnt(8)
    v_mfma_f32_32x32x16_bf16 v[48:63], a[44:47], v[192:195], v[48:63]
    ds_read_b64_tr_b16 v[180:181], v10 offset:40960
    ds_read_b64_tr_b16 v[182:183], v10 offset:41984
    buffer_store_dwordx4 v[244:247], v43, s[28:31], s74 offen offset:1024 sc1
    s_waitcnt lgkmcnt(8)
    v_mfma_f32_32x32x16_bf16 v[48:63], a[48:51], v[196:199], v[48:63]
    ds_read_b64_tr_b16 v[184:185], v10 offset:45056
    ds_read_b64_tr_b16 v[186:187], v10 offset:46080
    s_waitcnt lgkmcnt(8)
    v_mfma_f32_32x32x16_bf16 v[48:63], a[52:55], v[168:171], v[48:63]
    ds_read_b64_tr_b16 v[188:189], v10 offset:49152
    ds_read_b64_tr_b16 v[190:191], v10 offset:50176
    s_waitcnt lgkmcnt(8)
    v_mfma_f32_32x32x16_bf16 v[48:63], a[56:59], v[172:175], v[48:63]
    ds_read_b64_tr_b16 v[192:193], v10 offset:53248
    ds_read_b64_tr_b16 v[194:195], v10 offset:54272
    s_waitcnt lgkmcnt(8)
    v_mfma_f32_32x32x16_bf16 v[48:63], a[60:63], v[176:179], v[48:63]
    ds_read_b64_tr_b16 v[196:197], v10 offset:57344
    ds_read_b64_tr_b16 v[198:199], v10 offset:58368
    s_waitcnt lgkmcnt(8)
    v_mfma_f32_32x32x16_bf16 v[48:63], a[64:67], v[180:183], v[48:63]
    ds_read_b64_tr_b16 v[168:169], v10 offset:61440
    ds_read_b64_tr_b16 v[170:171], v10 offset:62464
    s_waitcnt lgkmcnt(8)
    v_mfma_f32_32x32x16_bf16 v[48:63], a[68:71], v[184:187], v[48:63]
    ds_read_b128 v[172:175], v18 offset:49152
    s_waitcnt lgkmcnt(7)
    v_mfma_f32_32x32x16_bf16 v[48:63], a[72:75], v[188:191], v[48:63]
    ds_read_b128 v[176:179], v19 offset:49152
    s_waitcnt lgkmcnt(6)
    v_mfma_f32_32x32x16_bf16 v[48:63], a[76:79], v[192:195], v[48:63]
    ds_read_b128 v[180:183], v20 offset:49152
    s_waitcnt lgkmcnt(5)
    v_mfma_f32_32x32x16_bf16 v[48:63], a[80:83], v[196:199], v[48:63]
    ds_read_b128 v[184:187], v21 offset:49152
    s_waitcnt lgkmcnt(4)
    v_mfma_f32_32x32x16_bf16 v[48:63], a[84:87], v[168:171], v[48:63]
    ds_read_b128 v[188:191], v22 offset:0
    s_waitcnt vmcnt(0)
    buffer_load_dword v97, v99, s[28:31], 0 offen sc1
    s_mov_b64 exec, 7
    buffer_store_dword v45, v98, s[28:31], 0 offen sc1
    s_mov_b64 exec, -1
    s_nop 1
    s_waitcnt lgkmcnt(4)
    v_mfma_f32_32x32x16_bf16 v[48:63], v[112:115], v[172:175], v[48:63]
    ds_read_b128 v[192:195], v23 offset:0
    s_waitcnt lgkmcnt(4)
    v_mfma_f32_32x32x16_bf16 v[48:63], v[116:119], v[176:179], v[48:63]
    ds_read_b128 v[196:199], v24 offset:0
    s_waitcnt lgkmcnt(4)
    v_mfma_f32_32x32x16_bf16 v[48:63], a[88:91], v[180:183], v[48:63]
    ds_read_b128 v[168:171], v25 offset:0
    s_waitcnt lgkmcnt(4)
    v_mfma_f32_32x32x16_bf16 v[48:63], a[92:95], v[184:187], v[48:63]
    ds_read_b128 v[172:175], v18 offset:0
    s_waitcnt lgkmcnt(4)
    v_mfma_f32_32x32x16_bf16 v[48:63], a[96:99], v[188:191], v[48:63]
    ds_read_b128 v[176:179], v19 offset:0
    s_waitcnt lgkmcnt(4)
    v_mfma_f32_32x32x16_bf16 v[48:63], a[100:103], v[192:195], v[48:63]
    ds_read_b128 v[180:183], v20 offset:0
    s_waitcnt lgkmcnt(4)
    v_mfma_f32_32x32x16_bf16 v[48:63], a[104:107], v[196:199], v[48:63]
    ds_read_b128 v[184:187], v21 offset:0
    s_waitcnt lgkmcnt(4)
    v_mfma_f32_32x32x16_bf16 v[48:63], a[108:111], v[168:171], v[48:63]
    ds_read_b128 v[188:191], v18 offset:16384
    s_waitcnt lgkmcnt(4)
    v_mfma_f32_32x32x16_bf16 v[48:63], v[128:131], v[172:175], v[48:63]
    ds_read_b128 v[192:195], v19 offset:16384
    s_waitcnt lgkmcnt(4)
    v_mfma_f32_32x32x16_bf16 v[48:63], v[132:135], v[176:179], v[48:63]
    ds_read_b128 v[196:199], v20 offset:16384
    s_waitcnt lgkmcnt(4)
    v_mfma_f32_32x32x16_bf16 v[48:63], a[112:115], v[180:183], v[48:63]
    ds_read_b128 v[168:171], v21 offset:16384
    s_waitcnt lgkmcnt(4)
    v_mfma_f32_32x32x16_bf16 v[48:63], a[116:119], v[184:187], v[48:63]
    s_waitcnt lgkmcnt(3)
    v_mfma_f32_32x32x16_bf16 v[48:63], a[120:123], v[188:191], v[48:63]
    s_waitcnt lgkmcnt(2)
    v_mfma_f32_32x32x16_bf16 v[48:63], a[124:127], v[192:195], v[48:63]
    s_waitcnt lgkmcnt(1)
    v_mfma_f32_32x32x16_bf16 v[48:63], a[128:131], v[196:199], v[48:63]
    s_waitcnt lgkmcnt(0)
    v_mfma_f32_32x32x16_bf16 v[48:63], a[132:135], v[168:171], v[48:63]
    v_mov_b32 v200, 0x3f80
    v_mov_b32_e64 v201, 0x3f800000
    s_cmp_eq_u32 s37, 15
    s_cselect_b32 s52, s38, 1
    s_or_b32 s52, s52, s36
    s_waitcnt vmcnt(1)
    s_mov_b32 s60, 0
L_f2_chk:
    v_cmp_ne_u32 vcc, s41, v97
    s_add_u32 s60, s60, 1
    s_cbranch_vccz L_f2_ok
    s_cmp_ge_u32 s60, 0x8000
    s_cbranch_scc1 L_f2_ok
    buffer_load_dword v97, v99, s[28:31], 0 offen sc1
    s_waitcnt vmcnt(0)
    s_branch L_f2_chk
L_f2_ok:
    s_add_u32 s49, s75, 4096
    buffer_load_dwordx4 v[72:75], v43, s[28:31], s75 offen offset:0 sc1
    buffer_load_dwordx4 v[76:79], v43, s[28:31], s75 offen offset:1024 sc1
    buffer_load_dwordx4 v[88:91], v43, s[28:31], s75 offen offset:2048 sc1
    buffer_load_dwordx4 v[92:95], v43, s[28:31], s75 offen offset:3072 sc1
    buffer_load_dwordx4 v[248:251], v43, s[28:31], s49 offen offset:0 sc1
    buffer_load_dwordx4 v[252:255], v43, s[28:31], s49 offen offset:1024 sc1
    s_waitcnt vmcnt(4)
    v_dot2c_f32_bf16 v48, v72, v200
    v_dot2c_f32_bf16 v49, v72, v201
    v_dot2c_f32_bf16 v50, v73, v200
    v_dot2c_f32_bf16 v51, v73, v201
    v_dot2c_f32_bf16 v52, v74, v200
    v_dot2c_f32_bf16 v53, v74, v201
    v_dot2c_f32_bf16 v54, v75, v200
    v_dot2c_f32_bf16 v55, v75, v201
    v_dot2c_f32_bf16 v56, v76, v200
    v_dot2c_f32_bf16 v57, v76, v201
    v_dot2c_f32_bf16 v58, v77, v200
    v_dot2c_f32_bf16 v59, v77, v201
    v_dot2c_f32_bf16 v60, v78, v200
    v_dot2c_f32_bf16 v61, v78, v201
    v_dot2c_f32_bf16 v62, v79, v200
    v_dot2c_f32_bf16 v63, v79, v201
    s_waitcnt vmcnt(2)
    v_dot2c_f32_bf16 v48, v88, v200
    v_dot2c_f32_bf16 v49, v88, v201
    v_dot2c_f32_bf16 v50, v89, v200
    v_dot2c_f32_bf16 v51, v89, v201
    v_dot2c_f32_bf16 v52, v90, v200
    v_dot2c_f32_bf16 v53, v90, v201
    v_dot2c_f32_bf16 v54, v91, v200
    v_dot2c_f32_bf16 v55, v91, v201
    v_dot2c_f32_bf16 v56, v92, v200
    v_dot2c_f32_bf16 v57, v92, v201
    v_dot2c_f32_bf16 v58, v93, v200
    v_dot2c_f32_bf16 v59, v93, v201
    v_dot2c_f32_bf16 v60, v94, v200
    v_dot2c_f32_bf16 v61, v94, v201
    v_dot2c_f32_bf16 v62, v95, v200
    v_dot2c_f32_bf16 v63, v95, v201
    s_waitcnt vmcnt(0)
    v_dot2c_f32_bf16 v48, v248, v200
    v_dot2c_f32_bf16 v49, v248, v201
    v_dot2c_f32_bf16 v50, v249, v200
    v_dot2c_f32_bf16 v51, v249, v201
    v_dot2c_f32_bf16 v52, v250, v200
    v_dot2c_f32_bf16 v53, v250, v201
    s_mov_b32 s49, 0
    buffer_store_dword v48, v44, s[32:35], s49 offen offset:0 nt
    buffer_store_dword v49, v44, s[32:35], s49 offen offset:2048 nt
    v_dot2c_f32_bf16 v54, v251, v200
    v_dot2c_f32_bf16 v55, v251, v201
    s_mov_b32 s49, 4096
    buffer_store_dword v50, v44, s[32:35], s49 offen offset:0 nt
    buffer_store_dword v51, v44, s[32:35], s49 offen offset:2048 nt
    v_dot2c_f32_bf16 v56, v252, v200
    v_dot2c_f32_bf16 v57, v252, v201
    s_mov_b32 s49, 65536
    buffer_store_dword v52, v44, s[32:35], s49 offen offset:0 nt
    buffer_store_dword v53, v44, s[32:35], s49 offen offset:2048 nt
    v_dot2c_f32_bf16 v58, v253, v200
    v_dot2c_f32_bf16 v59, v253, v201
    s_mov_b32 s49, 69632
    buffer_store_dword v54, v44, s[32:35], s49 offen offset:0 nt
    buffer_store_dword v55, v44, s[32:35], s49 offen offset:2048 nt
    v_dot2c_f32_bf16 v60, v254, v200
    v_dot2c_f32_bf16 v61, v254, v201
    s_mov_b32 s49, 8192
    buffer_store_dword v56, v44, s[32:35], s49 offen offset:0 nt
    buffer_store_dword v57, v44, s[32:35], s49 offen offset:2048 nt
    v_dot2c_f32_bf16 v62, v255, v200
    v_dot2c_f32_bf16 v63, v255, v201
    s_mov_b32 s49, 12288
    buffer_store_dword v58, v44, s[32:35], s49 offen offset:0 nt
    buffer_store_dword v59, v44, s[32:35], s49 offen offset:2048 nt
    s_mov_b32 s49, 73728
    s_nop 1
    buffer_store_dword v60, v44, s[32:35], s49 offen offset:0 nt
    buffer_store_dword v61, v44, s[32:35], s49 offen offset:2048 nt
    s_mov_b32 s49, 77824
    s_nop 1
    buffer_store_dword v62, v44, s[32:35], s49 offen offset:0 nt
    buffer_store_dword v63, v44, s[32:35], s49 offen offset:2048 nt
    s_cmp_lg_u32 s52, 0
    s_cbranch_scc1 L_end2
    s_mov_b64 exec, 1
    buffer_store_dword v45, off, s[28:31], 0 sc1
L_end2:
L_end:
    s_endpgm
.section .rodata,"a"
.p2align 6
.amdhsa_kernel gated_mix__ssm_conv_s5__dense_activation_relu__prompt_kernel
      .amdhsa_next_free_vgpr 512
      .amdhsa_next_free_sgpr 102
      .amdhsa_accum_offset 256
      .amdhsa_group_segment_fixed_size 0
      .amdhsa_kernarg_size 128
      .amdhsa_user_sgpr_count 2
      .amdhsa_user_sgpr_kernarg_segment_ptr 1
      .amdhsa_system_sgpr_workgroup_id_x 1
.end_amdhsa_kernel
```
